```python
import torch

def _softmax(x, axis=-1):
    return torch.softmax(x, dim=axis)
def _gelu(x):
    return torch.nn.functional.gelu(x, approximate="tanh")
def _silu(x):
    return torch.nn.functional.silu(x)
def _sigmoid(x):
    return torch.sigmoid(x)
def _layernorm(x, axis=-1, eps=1e-5):
    m = x.mean(dim=axis, keepdim=True)
    v = x.var(dim=axis, keepdim=True, unbiased=False)
    return (x - m) / torch.sqrt(v + eps)
def _scatter_add(tgt, idx, src, axis=0):
    return tgt.clone().index_add_(axis, idx, src)
def _segment_sum(src, seg, n):
    out = torch.zeros((n,) + src.shape[1:], dtype=src.dtype)
    return out.index_add_(0, seg, src)
def _pad(x, pw):
    flat = tuple(v for pair in reversed(pw) for v in pair)
    return torch.nn.functional.pad(x, flat)

kernel_name = 'recurrent_scan__sliding_block__glu_gated_geglu__prompt'

def setup_inputs():

    _w = (lambda a: (lambda t: t.to(torch.bfloat16) if t.is_floating_point() else t)(torch.as_tensor(a)))
    def _A_setup():
        B, S, D = 1, 2048, 512
        return {
            "x": _w((lambda *s: torch.randn(*s, dtype=torch.bfloat16) * 0.05)(B, S, D)),
            "wqkv": _w((lambda *s: torch.randn(*s, dtype=torch.bfloat16) * 0.2)(D, 3 * D)),
            "wo": _w((lambda *s: torch.randn(*s, dtype=torch.bfloat16) * 0.2)(D, D)),
        }
    _A_in = _A_setup()

    def _B_setup():
        B, S, Dm, Df = 1, 2048, 512, 1792
        return {
            "x": _w((lambda *s: torch.randn(*s, dtype=torch.bfloat16) * 0.05)(B, S, Dm)),
            "w_gate": _w((lambda *s: torch.randn(*s, dtype=torch.bfloat16) * 0.1)(Dm, Df) * (Dm ** -0.5)),
            "w_up": _w((lambda *s: torch.randn(*s, dtype=torch.bfloat16) * 0.1)(Dm, Df) * (Dm ** -0.5)),
            "w_down": _w((lambda *s: torch.randn(*s, dtype=torch.bfloat16) * 0.1)(Df, Dm) * (Df ** -0.5)),
        }
    _B_in = _B_setup()

    return {
        "A_x": _A_in["x"],
        "A_wqkv": _A_in["wqkv"],
        "A_wo": _A_in["wo"],
        "B_x": _B_in["x"],
        "B_w_gate": _B_in["w_gate"],
        "B_w_up": _B_in["w_up"],
        "B_w_down": _B_in["w_down"],
    }

def reference(A_x, A_wqkv, A_wo, B_x, B_w_gate, B_w_up, B_w_down):
    def _A_ref(x, wqkv, wo):
        B, S, D = x.shape
        H = 32; Dh = D // H; W = 256
        qkv = (lambda x, *d: x.permute(*d))((x @ wqkv).reshape(B, S, 3, H, Dh), 2, 0, 3, 1, 4)
        q, k, v = qkv[0], qkv[1], qkv[2]
        scores = torch.einsum("bhqd,bhkd->bhqk", q, k) * (Dh ** -0.5)
        idx = torch.arange(S)
        mask = (idx[:, None] - idx[None, :] >= 0) & (idx[:, None] - idx[None, :] < W)
        scores = torch.where(mask[None, None], scores, -1e9)
        p = _softmax(scores, axis=-1)
        o = torch.einsum("bhqk,bhkd->bhqd", p, v)
        return (lambda x, *d: x.permute(*d))(o, 0, 2, 1, 3).reshape(B, S, D) @ wo

    def _B_ref(x, w_gate, w_up, w_down):
        g = torch.einsum("bsd,df->bsf", x, w_gate)
        u = torch.einsum("bsd,df->bsf", x, w_up)
        h = _gelu(g) * u
        return torch.einsum("bsf,fd->bsd", h, w_down)

    x = A_x
    xn = _layernorm(x, axis=-1)
    s = _A_ref(xn, A_wqkv, A_wo)
    g = _silu(_B_ref(xn, B_w_gate, B_w_up, B_w_down))
    return x + s * g
```

```asm
; @launch kernel=k1_kernel grid=(256,1,1) block=(512,1,1) lds=114688
; @launch kernel=k2_kernel grid=(512,1,1) block=(256,1,1) lds=24576
; @launch kernel=recurrent_scan__sliding_block__glu_gated_geglu__prompt_kernel grid=(256,1,1) block=(256,1,1) lds=131072
.amdgcn_target "amdgcn-amd-amdhsa--gfx950"
.text
.globl k1_kernel
.p2align 8
.type k1_kernel,@function
k1_kernel:
  s_cmp_ge_u32 s2, 256
  s_cbranch_scc1 k1_end
  s_load_dwordx2 s[4:5], s[0:1], 0
  s_load_dwordx2 s[6:7], s[0:1], 8
  s_load_dwordx4 s[8:11], s[0:1], 32
  s_load_dwordx2 s[12:13], s[0:1], 72
  s_lshr_b32 s14, s2, 4
  s_and_b32 s15, s2, 15
  v_and_b32 v1, 63, v0
  v_lshrrev_b32 v2, 6, v0
  s_nop 0
  v_readfirstlane_b32 s16, v2
  s_lshl_b32 s17, s14, 7
  s_lshl_b32 s18, s16, 4
  s_add_u32 s17, s17, s18
  s_lshl_b32 s18, s17, 10
  v_lshrrev_b32 v3, 3, v1
  v_and_b32 v4, 7, v1
  v_lshlrev_b32 v5, 10, v3
  v_lshl_add_u32 v5, v4, 4, v5
  v_add_u32 v242, s18, v5
  v_add_u32 v243, 0x2000, v242
  s_waitcnt lgkmcnt(0)
  global_load_dwordx4 v[20:23], v242, s[4:5] offset:0
  global_load_dwordx4 v[24:27], v242, s[4:5] offset:128
  global_load_dwordx4 v[28:31], v242, s[4:5] offset:256
  global_load_dwordx4 v[32:35], v242, s[4:5] offset:384
  global_load_dwordx4 v[36:39], v242, s[4:5] offset:512
  global_load_dwordx4 v[40:43], v242, s[4:5] offset:640
  global_load_dwordx4 v[44:47], v242, s[4:5] offset:768
  global_load_dwordx4 v[48:51], v242, s[4:5] offset:896
  global_load_dwordx4 v[52:55], v243, s[4:5] offset:0
  global_load_dwordx4 v[56:59], v243, s[4:5] offset:128
  global_load_dwordx4 v[60:63], v243, s[4:5] offset:256
  global_load_dwordx4 v[64:67], v243, s[4:5] offset:384
  global_load_dwordx4 v[68:71], v243, s[4:5] offset:512
  global_load_dwordx4 v[72:75], v243, s[4:5] offset:640
  global_load_dwordx4 v[76:79], v243, s[4:5] offset:768
  global_load_dwordx4 v[80:83], v243, s[4:5] offset:896
  v_lshrrev_b32 v6, 4, v1
  v_add_u32 v7, 0, v6
  v_xor_b32 v7, v4, v7
  v_lshlrev_b32 v7, 4, v7
  v_lshl_add_u32 v7, v3, 7, v7
  s_lshl_b32 s19, s16, 11
  s_add_u32 s19, s19, 81920
  v_add_u32 v244, s19, v7
  v_add_u32 v7, 4, v6
  v_xor_b32 v7, v4, v7
  v_lshlrev_b32 v7, 4, v7
  v_lshl_add_u32 v7, v3, 7, v7
  s_lshl_b32 s19, s16, 11
  s_add_u32 s19, s19, 82944
  v_add_u32 v245, s19, v7
  s_and_b32 s20, s16, 3
  s_lshr_b32 s21, s16, 2
  v_and_b32 v7, 31, v1
  v_lshlrev_b32 v7, 7, v7
  s_lshl_b32 s19, s20, 12
  s_add_u32 s19, s19, 81920
  v_add_u32 v7, s19, v7
  v_lshrrev_b32 v8, 1, v1
  v_and_b32 v8, 7, v8
  v_lshrrev_b32 v9, 5, v1
  v_and_b32 v84, 1, v8
  v_xor_b32 v9, v9, v84
  v_lshrrev_b32 v8, 1, v8
  v_xor_b32 v84, 0, v8
  v_lshl_or_b32 v84, v84, 1, v9
  v_lshl_add_u32 v246, v84, 4, v7
  v_xor_b32 v84, 1, v8
  v_lshl_or_b32 v84, v84, 1, v9
  v_lshl_add_u32 v247, v84, 4, v7
  v_xor_b32 v84, 2, v8
  v_lshl_or_b32 v84, v84, 1, v9
  v_lshl_add_u32 v248, v84, 4, v7
  v_xor_b32 v84, 3, v8
  v_lshl_or_b32 v84, v84, 1, v9
  v_lshl_add_u32 v249, v84, 4, v7
  v_lshrrev_b32 v7, 4, v1
  v_and_b32 v8, 15, v1
  v_lshrrev_b32 v9, 1, v7
  v_lshlrev_b32 v9, 3, v9
  v_lshrrev_b32 v84, 2, v8
  v_add_u32 v9, v9, v84
  v_lshlrev_b32 v9, 7, v9
  v_and_b32 v84, 3, v8
  v_lshl_add_u32 v9, v84, 3, v9
  v_and_b32 v84, 1, v7
  v_lshrrev_b32 v85, 3, v8
  v_lshlrev_b32 v86, 1, v85
  v_add_u32 v87, 0, v84
  v_xor_b32 v87, v87, v86
  v_lshl_add_u32 v90, v87, 5, v9
  v_add_u32 v87, 2, v84
  v_xor_b32 v87, v87, v86
  v_lshl_add_u32 v91, v87, 5, v9
  v_xor_b32 v86, 1, v84
  v_lshl_or_b32 v86, v86, 1, v85
  v_lshl_add_u32 v9, v84, 13, v9
  v_add_u32 v9, 0x2000, v9
  v_xor_b32 v87, 0, v86
  v_lshl_add_u32 v92, v87, 5, v9
  v_xor_b32 v87, 1, v86
  v_lshl_add_u32 v93, v87, 5, v9
  v_xor_b32 v87, 2, v86
  v_lshl_add_u32 v94, v87, 5, v9
  v_xor_b32 v87, 3, v86
  v_lshl_add_u32 v95, v87, 5, v9
  v_lshrrev_b32 v7, 3, v1
  v_and_b32 v8, 7, v1
  v_lshrrev_b32 v85, 4, v1
  v_and_b32 v85, 1, v85
  s_mul_i32 s22, s16, 5
  s_sub_u32 s24, s15, 14
  s_mul_i32 s24, s24, 5
  s_add_u32 s24, s24, 14
  s_cmp_lt_u32 s15, 14
  s_cselect_b32 s42, s15, s24
  s_add_u32 s24, s22, 0
  s_lshr_b32 s25, s24, 3
  s_and_b32 s26, s24, 7
  s_and_b32 s28, s25, 1
  s_lshl_b32 s28, s28, 2
  s_cmp_eq_u32 s25, 0
  s_cselect_b32 s29, 2, 1
  s_cselect_b32 s28, 0, s28
  v_mul_lo_u32 v86, v85, s29
  v_lshlrev_b32 v86, 1, v86
  v_or_b32 v86, s28, v86
  v_xor_b32 v86, v8, v86
  v_lshlrev_b32 v86, 4, v86
  s_add_u32 s30, s42, s25
  s_lshl_b32 s30, s30, 7
  s_add_u32 s30, s6, s30
  s_addc_u32 s31, s7, 0
  s_sub_u32 s32, s25, 1
  s_lshr_b32 s32, s32, 1
  s_lshl_b32 s33, s15, 1
  s_add_u32 s32, s32, s33
  s_lshl_b32 s32, s32, 7
  s_bitcmp1_b32 s25, 0
  s_cselect_b32 s34, s8, s10
  s_cselect_b32 s35, s9, s11
  s_add_u32 s34, s34, s32
  s_addc_u32 s35, s35, 0
  s_cmp_lg_u32 s25, 0
  s_cselect_b32 s27, 1, 0
  s_cmp_lt_u32 s15, 14
  s_cselect_b32 s27, s27, 0
  s_cmp_lg_u32 s27, 0
  s_cselect_b32 s30, s34, s30
  s_cselect_b32 s31, s35, s31
  s_movk_i32 s27, 3584
  s_cselect_b32 s27, s27, 3072
  s_lshl_b32 s44, s27, 6
  s_lshl_b32 s26, s26, 3
  v_add_u32 v9, s26, v7
  v_mul_lo_u32 v9, v9, s27
  v_add_u32 v9, v9, v86
  v_add_co_u32 v10, vcc, s30, v9
  v_mov_b32 v11, s31
  v_addc_co_u32 v11, vcc, 0, v11, vcc
  s_add_u32 s24, s22, 1
  s_lshr_b32 s25, s24, 3
  s_and_b32 s26, s24, 7
  s_and_b32 s28, s25, 1
  s_lshl_b32 s28, s28, 2
  s_cmp_eq_u32 s25, 0
  s_cselect_b32 s29, 2, 1
  s_cselect_b32 s28, 0, s28
  v_mul_lo_u32 v86, v85, s29
  v_lshlrev_b32 v86, 1, v86
  v_or_b32 v86, s28, v86
  v_xor_b32 v86, v8, v86
  v_lshlrev_b32 v86, 4, v86
  s_add_u32 s30, s42, s25
  s_lshl_b32 s30, s30, 7
  s_add_u32 s30, s6, s30
  s_addc_u32 s31, s7, 0
  s_sub_u32 s32, s25, 1
  s_lshr_b32 s32, s32, 1
  s_lshl_b32 s33, s15, 1
  s_add_u32 s32, s32, s33
  s_lshl_b32 s32, s32, 7
  s_bitcmp1_b32 s25, 0
  s_cselect_b32 s34, s8, s10
  s_cselect_b32 s35, s9, s11
  s_add_u32 s34, s34, s32
  s_addc_u32 s35, s35, 0
  s_cmp_lg_u32 s25, 0
  s_cselect_b32 s27, 1, 0
  s_cmp_lt_u32 s15, 14
  s_cselect_b32 s27, s27, 0
  s_cmp_lg_u32 s27, 0
  s_cselect_b32 s30, s34, s30
  s_cselect_b32 s31, s35, s31
  s_movk_i32 s27, 3584
  s_cselect_b32 s27, s27, 3072
  s_lshl_b32 s45, s27, 6
  s_lshl_b32 s26, s26, 3
  v_add_u32 v9, s26, v7
  v_mul_lo_u32 v9, v9, s27
  v_add_u32 v9, v9, v86
  v_add_co_u32 v12, vcc, s30, v9
  v_mov_b32 v13, s31
  v_addc_co_u32 v13, vcc, 0, v13, vcc
  s_add_u32 s24, s22, 2
  s_lshr_b32 s25, s24, 3
  s_and_b32 s26, s24, 7
  s_and_b32 s28, s25, 1
  s_lshl_b32 s28, s28, 2
  s_cmp_eq_u32 s25, 0
  s_cselect_b32 s29, 2, 1
  s_cselect_b32 s28, 0, s28
  v_mul_lo_u32 v86, v85, s29
  v_lshlrev_b32 v86, 1, v86
  v_or_b32 v86, s28, v86
  v_xor_b32 v86, v8, v86
  v_lshlrev_b32 v86, 4, v86
  s_add_u32 s30, s42, s25
  s_lshl_b32 s30, s30, 7
  s_add_u32 s30, s6, s30
  s_addc_u32 s31, s7, 0
  s_sub_u32 s32, s25, 1
  s_lshr_b32 s32, s32, 1
  s_lshl_b32 s33, s15, 1
  s_add_u32 s32, s32, s33
  s_lshl_b32 s32, s32, 7
  s_bitcmp1_b32 s25, 0
  s_cselect_b32 s34, s8, s10
  s_cselect_b32 s35, s9, s11
  s_add_u32 s34, s34, s32
  s_addc_u32 s35, s35, 0
  s_cmp_lg_u32 s25, 0
  s_cselect_b32 s27, 1, 0
  s_cmp_lt_u32 s15, 14
  s_cselect_b32 s27, s27, 0
  s_cmp_lg_u32 s27, 0
  s_cselect_b32 s30, s34, s30
  s_cselect_b32 s31, s35, s31
  s_movk_i32 s27, 3584
  s_cselect_b32 s27, s27, 3072
  s_lshl_b32 s46, s27, 6
  s_lshl_b32 s26, s26, 3
  v_add_u32 v9, s26, v7
  v_mul_lo_u32 v9, v9, s27
  v_add_u32 v9, v9, v86
  v_add_co_u32 v14, vcc, s30, v9
  v_mov_b32 v15, s31
  v_addc_co_u32 v15, vcc, 0, v15, vcc
  s_add_u32 s24, s22, 3
  s_lshr_b32 s25, s24, 3
  s_and_b32 s26, s24, 7
  s_and_b32 s28, s25, 1
  s_lshl_b32 s28, s28, 2
  s_cmp_eq_u32 s25, 0
  s_cselect_b32 s29, 2, 1
  s_cselect_b32 s28, 0, s28
  v_mul_lo_u32 v86, v85, s29
  v_lshlrev_b32 v86, 1, v86
  v_or_b32 v86, s28, v86
  v_xor_b32 v86, v8, v86
  v_lshlrev_b32 v86, 4, v86
  s_add_u32 s30, s42, s25
  s_lshl_b32 s30, s30, 7
  s_add_u32 s30, s6, s30
  s_addc_u32 s31, s7, 0
  s_sub_u32 s32, s25, 1
  s_lshr_b32 s32, s32, 1
  s_lshl_b32 s33, s15, 1
  s_add_u32 s32, s32, s33
  s_lshl_b32 s32, s32, 7
  s_bitcmp1_b32 s25, 0
  s_cselect_b32 s34, s8, s10
  s_cselect_b32 s35, s9, s11
  s_add_u32 s34, s34, s32
  s_addc_u32 s35, s35, 0
  s_cmp_lg_u32 s25, 0
  s_cselect_b32 s27, 1, 0
  s_cmp_lt_u32 s15, 14
  s_cselect_b32 s27, s27, 0
  s_cmp_lg_u32 s27, 0
  s_cselect_b32 s30, s34, s30
  s_cselect_b32 s31, s35, s31
  s_movk_i32 s27, 3584
  s_cselect_b32 s27, s27, 3072
  s_lshl_b32 s47, s27, 6
  s_lshl_b32 s26, s26, 3
  v_add_u32 v9, s26, v7
  v_mul_lo_u32 v9, v9, s27
  v_add_u32 v9, v9, v86
  v_add_co_u32 v16, vcc, s30, v9
  v_mov_b32 v17, s31
  v_addc_co_u32 v17, vcc, 0, v17, vcc
  s_add_u32 s24, s22, 4
  s_lshr_b32 s25, s24, 3
  s_and_b32 s26, s24, 7
  s_and_b32 s28, s25, 1
  s_lshl_b32 s28, s28, 2
  s_cmp_eq_u32 s25, 0
  s_cselect_b32 s29, 2, 1
  s_cselect_b32 s28, 0, s28
  v_mul_lo_u32 v86, v85, s29
  v_lshlrev_b32 v86, 1, v86
  v_or_b32 v86, s28, v86
  v_xor_b32 v86, v8, v86
  v_lshlrev_b32 v86, 4, v86
  s_add_u32 s30, s42, s25
  s_lshl_b32 s30, s30, 7
  s_add_u32 s30, s6, s30
  s_addc_u32 s31, s7, 0
  s_sub_u32 s32, s25, 1
  s_lshr_b32 s32, s32, 1
  s_lshl_b32 s33, s15, 1
  s_add_u32 s32, s32, s33
  s_lshl_b32 s32, s32, 7
  s_bitcmp1_b32 s25, 0
  s_cselect_b32 s34, s8, s10
  s_cselect_b32 s35, s9, s11
  s_add_u32 s34, s34, s32
  s_addc_u32 s35, s35, 0
  s_cmp_lg_u32 s25, 0
  s_cselect_b32 s27, 1, 0
  s_cmp_lt_u32 s15, 14
  s_cselect_b32 s27, s27, 0
  s_cmp_lg_u32 s27, 0
  s_cselect_b32 s30, s34, s30
  s_cselect_b32 s31, s35, s31
  s_movk_i32 s27, 3584
  s_cselect_b32 s27, s27, 3072
  s_lshl_b32 s48, s27, 6
  s_lshl_b32 s26, s26, 3
  v_add_u32 v9, s26, v7
  v_mul_lo_u32 v9, v9, s27
  v_add_u32 v9, v9, v86
  v_add_co_u32 v18, vcc, s30, v9
  v_mov_b32 v19, s31
  v_addc_co_u32 v19, vcc, 0, v19, vcc
  s_lshl_b32 s50, s22, 10
  s_cmp_eq_u32 s21, 0
  s_cselect_b64 s[40:41], -1, 0
  v_mov_b32 v84, v95
  v_cndmask_b32 v250, v84, v90, s[40:41]
  v_add_u32 v84, 0x4000, v92
  v_cndmask_b32 v251, v84, v91, s[40:41]
  v_add_u32 v84, 0x4000, v93
  v_cndmask_b32 v252, v84, v92, s[40:41]
  v_add_u32 v84, 0x4000, v94
  v_cndmask_b32 v253, v84, v93, s[40:41]
  v_add_u32 v84, 0x4000, v95
  v_cndmask_b32 v254, v84, v94, s[40:41]
  s_add_u32 m0, s50, 0
  s_nop 0
  global_load_lds_dwordx4 v[10:11], off
  v_add_co_u32 v10, vcc, s44, v10
  v_addc_co_u32 v11, vcc, 0, v11, vcc
  s_add_u32 m0, s50, 1024
  s_nop 0
  global_load_lds_dwordx4 v[12:13], off
  v_add_co_u32 v12, vcc, s45, v12
  v_addc_co_u32 v13, vcc, 0, v13, vcc
  s_add_u32 m0, s50, 2048
  s_nop 0
  global_load_lds_dwordx4 v[14:15], off
  v_add_co_u32 v14, vcc, s46, v14
  v_addc_co_u32 v15, vcc, 0, v15, vcc
  s_add_u32 m0, s50, 3072
  s_nop 0
  global_load_lds_dwordx4 v[16:17], off
  v_add_co_u32 v16, vcc, s47, v16
  v_addc_co_u32 v17, vcc, 0, v17, vcc
  s_add_u32 m0, s50, 4096
  s_nop 0
  global_load_lds_dwordx4 v[18:19], off
  v_add_co_u32 v18, vcc, s48, v18
  v_addc_co_u32 v19, vcc, 0, v19, vcc
  s_add_u32 m0, s50, 40960
  s_nop 0
  global_load_lds_dwordx4 v[10:11], off
  v_add_co_u32 v10, vcc, s44, v10
  v_addc_co_u32 v11, vcc, 0, v11, vcc
  s_add_u32 m0, s50, 41984
  s_nop 0
  global_load_lds_dwordx4 v[12:13], off
  v_add_co_u32 v12, vcc, s45, v12
  v_addc_co_u32 v13, vcc, 0, v13, vcc
  s_add_u32 m0, s50, 43008
  s_nop 0
  global_load_lds_dwordx4 v[14:15], off
  v_add_co_u32 v14, vcc, s46, v14
  v_addc_co_u32 v15, vcc, 0, v15, vcc
  s_add_u32 m0, s50, 44032
  s_nop 0
  global_load_lds_dwordx4 v[16:17], off
  v_add_co_u32 v16, vcc, s47, v16
  v_addc_co_u32 v17, vcc, 0, v17, vcc
  s_add_u32 m0, s50, 45056
  s_nop 0
  global_load_lds_dwordx4 v[18:19], off
  v_add_co_u32 v18, vcc, s48, v18
  v_addc_co_u32 v19, vcc, 0, v19, vcc
  s_waitcnt vmcnt(10)
  v_mov_b32 v86, 0
  v_mov_b32 v87, 0
  s_mov_b32 s24, 0x3f803f80
  v_lshlrev_b32 v84, 16, v20
  v_and_b32 v85, 0xffff0000, v20
  v_pk_add_f32 v[86:87], v[84:85], v[86:87]
  v_lshlrev_b32 v84, 16, v21
  v_and_b32 v85, 0xffff0000, v21
  v_pk_add_f32 v[86:87], v[84:85], v[86:87]
  v_lshlrev_b32 v84, 16, v22
  v_and_b32 v85, 0xffff0000, v22
  v_pk_add_f32 v[86:87], v[84:85], v[86:87]
  v_lshlrev_b32 v84, 16, v23
  v_and_b32 v85, 0xffff0000, v23
  v_pk_add_f32 v[86:87], v[84:85], v[86:87]
  v_lshlrev_b32 v84, 16, v24
  v_and_b32 v85, 0xffff0000, v24
  v_pk_add_f32 v[86:87], v[84:85], v[86:87]
  v_lshlrev_b32 v84, 16, v25
  v_and_b32 v85, 0xffff0000, v25
  v_pk_add_f32 v[86:87], v[84:85], v[86:87]
  v_lshlrev_b32 v84, 16, v26
  v_and_b32 v85, 0xffff0000, v26
  v_pk_add_f32 v[86:87], v[84:85], v[86:87]
  v_lshlrev_b32 v84, 16, v27
  v_and_b32 v85, 0xffff0000, v27
  v_pk_add_f32 v[86:87], v[84:85], v[86:87]
  v_lshlrev_b32 v84, 16, v28
  v_and_b32 v85, 0xffff0000, v28
  v_pk_add_f32 v[86:87], v[84:85], v[86:87]
  v_lshlrev_b32 v84, 16, v29
  v_and_b32 v85, 0xffff0000, v29
  v_pk_add_f32 v[86:87], v[84:85], v[86:87]
  v_lshlrev_b32 v84, 16, v30
  v_and_b32 v85, 0xffff0000, v30
  v_pk_add_f32 v[86:87], v[84:85], v[86:87]
  v_lshlrev_b32 v84, 16, v31
  v_and_b32 v85, 0xffff0000, v31
  v_pk_add_f32 v[86:87], v[84:85], v[86:87]
  v_lshlrev_b32 v84, 16, v32
  v_and_b32 v85, 0xffff0000, v32
  v_pk_add_f32 v[86:87], v[84:85], v[86:87]
  v_lshlrev_b32 v84, 16, v33
  v_and_b32 v85, 0xffff0000, v33
  v_pk_add_f32 v[86:87], v[84:85], v[86:87]
  v_lshlrev_b32 v84, 16, v34
  v_and_b32 v85, 0xffff0000, v34
  v_pk_add_f32 v[86:87], v[84:85], v[86:87]
  v_lshlrev_b32 v84, 16, v35
  v_and_b32 v85, 0xffff0000, v35
  v_pk_add_f32 v[86:87], v[84:85], v[86:87]
  v_lshlrev_b32 v84, 16, v36
  v_and_b32 v85, 0xffff0000, v36
  v_pk_add_f32 v[86:87], v[84:85], v[86:87]
  v_lshlrev_b32 v84, 16, v37
  v_and_b32 v85, 0xffff0000, v37
  v_pk_add_f32 v[86:87], v[84:85], v[86:87]
  v_lshlrev_b32 v84, 16, v38
  v_and_b32 v85, 0xffff0000, v38
  v_pk_add_f32 v[86:87], v[84:85], v[86:87]
  v_lshlrev_b32 v84, 16, v39
  v_and_b32 v85, 0xffff0000, v39
  v_pk_add_f32 v[86:87], v[84:85], v[86:87]
  v_lshlrev_b32 v84, 16, v40
  v_and_b32 v85, 0xffff0000, v40
  v_pk_add_f32 v[86:87], v[84:85], v[86:87]
  v_lshlrev_b32 v84, 16, v41
  v_and_b32 v85, 0xffff0000, v41
  v_pk_add_f32 v[86:87], v[84:85], v[86:87]
  v_lshlrev_b32 v84, 16, v42
  v_and_b32 v85, 0xffff0000, v42
  v_pk_add_f32 v[86:87], v[84:85], v[86:87]
  v_lshlrev_b32 v84, 16, v43
  v_and_b32 v85, 0xffff0000, v43
  v_pk_add_f32 v[86:87], v[84:85], v[86:87]
  v_lshlrev_b32 v84, 16, v44
  v_and_b32 v85, 0xffff0000, v44
  v_pk_add_f32 v[86:87], v[84:85], v[86:87]
  v_lshlrev_b32 v84, 16, v45
  v_and_b32 v85, 0xffff0000, v45
  v_pk_add_f32 v[86:87], v[84:85], v[86:87]
  v_lshlrev_b32 v84, 16, v46
  v_and_b32 v85, 0xffff0000, v46
  v_pk_add_f32 v[86:87], v[84:85], v[86:87]
  v_lshlrev_b32 v84, 16, v47
  v_and_b32 v85, 0xffff0000, v47
  v_pk_add_f32 v[86:87], v[84:85], v[86:87]
  v_lshlrev_b32 v84, 16, v48
  v_and_b32 v85, 0xffff0000, v48
  v_pk_add_f32 v[86:87], v[84:85], v[86:87]
  v_lshlrev_b32 v84, 16, v49
  v_and_b32 v85, 0xffff0000, v49
  v_pk_add_f32 v[86:87], v[84:85], v[86:87]
  v_lshlrev_b32 v84, 16, v50
  v_and_b32 v85, 0xffff0000, v50
  v_pk_add_f32 v[86:87], v[84:85], v[86:87]
  v_lshlrev_b32 v84, 16, v51
  v_and_b32 v85, 0xffff0000, v51
  v_pk_add_f32 v[86:87], v[84:85], v[86:87]
  v_add_f32 v86, v86, v87
  s_nop 1
  v_add_f32_dpp v86, v86, v86 quad_perm:[1,0,3,2] row_mask:0xf bank_mask:0xf
  s_nop 1
  v_add_f32_dpp v86, v86, v86 quad_perm:[2,3,0,1] row_mask:0xf bank_mask:0xf
  s_nop 1
  v_add_f32_dpp v86, v86, v86 row_half_mirror row_mask:0xf bank_mask:0xf
  v_mul_f32 v86, 0x3b000000, v86
  v_mov_b32 v87, v86
  v_mov_b32 v88, 0
  v_mov_b32 v89, 0
  v_lshlrev_b32 v84, 16, v20
  v_and_b32 v85, 0xffff0000, v20
  v_pk_add_f32 v[84:85], v[84:85], v[86:87] neg_lo:[0,1] neg_hi:[0,1]
  v_pk_fma_f32 v[88:89], v[84:85], v[84:85], v[88:89]
  v_lshlrev_b32 v84, 16, v21
  v_and_b32 v85, 0xffff0000, v21
  v_pk_add_f32 v[84:85], v[84:85], v[86:87] neg_lo:[0,1] neg_hi:[0,1]
  v_pk_fma_f32 v[88:89], v[84:85], v[84:85], v[88:89]
  v_lshlrev_b32 v84, 16, v22
  v_and_b32 v85, 0xffff0000, v22
  v_pk_add_f32 v[84:85], v[84:85], v[86:87] neg_lo:[0,1] neg_hi:[0,1]
  v_pk_fma_f32 v[88:89], v[84:85], v[84:85], v[88:89]
  v_lshlrev_b32 v84, 16, v23
  v_and_b32 v85, 0xffff0000, v23
  v_pk_add_f32 v[84:85], v[84:85], v[86:87] neg_lo:[0,1] neg_hi:[0,1]
  v_pk_fma_f32 v[88:89], v[84:85], v[84:85], v[88:89]
  v_lshlrev_b32 v84, 16, v24
  v_and_b32 v85, 0xffff0000, v24
  v_pk_add_f32 v[84:85], v[84:85], v[86:87] neg_lo:[0,1] neg_hi:[0,1]
  v_pk_fma_f32 v[88:89], v[84:85], v[84:85], v[88:89]
  v_lshlrev_b32 v84, 16, v25
  v_and_b32 v85, 0xffff0000, v25
  v_pk_add_f32 v[84:85], v[84:85], v[86:87] neg_lo:[0,1] neg_hi:[0,1]
  v_pk_fma_f32 v[88:89], v[84:85], v[84:85], v[88:89]
  v_lshlrev_b32 v84, 16, v26
  v_and_b32 v85, 0xffff0000, v26
  v_pk_add_f32 v[84:85], v[84:85], v[86:87] neg_lo:[0,1] neg_hi:[0,1]
  v_pk_fma_f32 v[88:89], v[84:85], v[84:85], v[88:89]
  v_lshlrev_b32 v84, 16, v27
  v_and_b32 v85, 0xffff0000, v27
  v_pk_add_f32 v[84:85], v[84:85], v[86:87] neg_lo:[0,1] neg_hi:[0,1]
  v_pk_fma_f32 v[88:89], v[84:85], v[84:85], v[88:89]
  v_lshlrev_b32 v84, 16, v28
  v_and_b32 v85, 0xffff0000, v28
  v_pk_add_f32 v[84:85], v[84:85], v[86:87] neg_lo:[0,1] neg_hi:[0,1]
  v_pk_fma_f32 v[88:89], v[84:85], v[84:85], v[88:89]
  v_lshlrev_b32 v84, 16, v29
  v_and_b32 v85, 0xffff0000, v29
  v_pk_add_f32 v[84:85], v[84:85], v[86:87] neg_lo:[0,1] neg_hi:[0,1]
  v_pk_fma_f32 v[88:89], v[84:85], v[84:85], v[88:89]
  v_lshlrev_b32 v84, 16, v30
  v_and_b32 v85, 0xffff0000, v30
  v_pk_add_f32 v[84:85], v[84:85], v[86:87] neg_lo:[0,1] neg_hi:[0,1]
  v_pk_fma_f32 v[88:89], v[84:85], v[84:85], v[88:89]
  v_lshlrev_b32 v84, 16, v31
  v_and_b32 v85, 0xffff0000, v31
  v_pk_add_f32 v[84:85], v[84:85], v[86:87] neg_lo:[0,1] neg_hi:[0,1]
  v_pk_fma_f32 v[88:89], v[84:85], v[84:85], v[88:89]
  v_lshlrev_b32 v84, 16, v32
  v_and_b32 v85, 0xffff0000, v32
  v_pk_add_f32 v[84:85], v[84:85], v[86:87] neg_lo:[0,1] neg_hi:[0,1]
  v_pk_fma_f32 v[88:89], v[84:85], v[84:85], v[88:89]
  v_lshlrev_b32 v84, 16, v33
  v_and_b32 v85, 0xffff0000, v33
  v_pk_add_f32 v[84:85], v[84:85], v[86:87] neg_lo:[0,1] neg_hi:[0,1]
  v_pk_fma_f32 v[88:89], v[84:85], v[84:85], v[88:89]
  v_lshlrev_b32 v84, 16, v34
  v_and_b32 v85, 0xffff0000, v34
  v_pk_add_f32 v[84:85], v[84:85], v[86:87] neg_lo:[0,1] neg_hi:[0,1]
  v_pk_fma_f32 v[88:89], v[84:85], v[84:85], v[88:89]
  v_lshlrev_b32 v84, 16, v35
  v_and_b32 v85, 0xffff0000, v35
  v_pk_add_f32 v[84:85], v[84:85], v[86:87] neg_lo:[0,1] neg_hi:[0,1]
  v_pk_fma_f32 v[88:89], v[84:85], v[84:85], v[88:89]
  v_lshlrev_b32 v84, 16, v36
  v_and_b32 v85, 0xffff0000, v36
  v_pk_add_f32 v[84:85], v[84:85], v[86:87] neg_lo:[0,1] neg_hi:[0,1]
  v_pk_fma_f32 v[88:89], v[84:85], v[84:85], v[88:89]
  v_lshlrev_b32 v84, 16, v37
  v_and_b32 v85, 0xffff0000, v37
  v_pk_add_f32 v[84:85], v[84:85], v[86:87] neg_lo:[0,1] neg_hi:[0,1]
  v_pk_fma_f32 v[88:89], v[84:85], v[84:85], v[88:89]
  v_lshlrev_b32 v84, 16, v38
  v_and_b32 v85, 0xffff0000, v38
  v_pk_add_f32 v[84:85], v[84:85], v[86:87] neg_lo:[0,1] neg_hi:[0,1]
  v_pk_fma_f32 v[88:89], v[84:85], v[84:85], v[88:89]
  v_lshlrev_b32 v84, 16, v39
  v_and_b32 v85, 0xffff0000, v39
  v_pk_add_f32 v[84:85], v[84:85], v[86:87] neg_lo:[0,1] neg_hi:[0,1]
  v_pk_fma_f32 v[88:89], v[84:85], v[84:85], v[88:89]
  v_lshlrev_b32 v84, 16, v40
  v_and_b32 v85, 0xffff0000, v40
  v_pk_add_f32 v[84:85], v[84:85], v[86:87] neg_lo:[0,1] neg_hi:[0,1]
  v_pk_fma_f32 v[88:89], v[84:85], v[84:85], v[88:89]
  v_lshlrev_b32 v84, 16, v41
  v_and_b32 v85, 0xffff0000, v41
  v_pk_add_f32 v[84:85], v[84:85], v[86:87] neg_lo:[0,1] neg_hi:[0,1]
  v_pk_fma_f32 v[88:89], v[84:85], v[84:85], v[88:89]
  v_lshlrev_b32 v84, 16, v42
  v_and_b32 v85, 0xffff0000, v42
  v_pk_add_f32 v[84:85], v[84:85], v[86:87] neg_lo:[0,1] neg_hi:[0,1]
  v_pk_fma_f32 v[88:89], v[84:85], v[84:85], v[88:89]
  v_lshlrev_b32 v84, 16, v43
  v_and_b32 v85, 0xffff0000, v43
  v_pk_add_f32 v[84:85], v[84:85], v[86:87] neg_lo:[0,1] neg_hi:[0,1]
  v_pk_fma_f32 v[88:89], v[84:85], v[84:85], v[88:89]
  v_lshlrev_b32 v84, 16, v44
  v_and_b32 v85, 0xffff0000, v44
  v_pk_add_f32 v[84:85], v[84:85], v[86:87] neg_lo:[0,1] neg_hi:[0,1]
  v_pk_fma_f32 v[88:89], v[84:85], v[84:85], v[88:89]
  v_lshlrev_b32 v84, 16, v45
  v_and_b32 v85, 0xffff0000, v45
  v_pk_add_f32 v[84:85], v[84:85], v[86:87] neg_lo:[0,1] neg_hi:[0,1]
  v_pk_fma_f32 v[88:89], v[84:85], v[84:85], v[88:89]
  v_lshlrev_b32 v84, 16, v46
  v_and_b32 v85, 0xffff0000, v46
  v_pk_add_f32 v[84:85], v[84:85], v[86:87] neg_lo:[0,1] neg_hi:[0,1]
  v_pk_fma_f32 v[88:89], v[84:85], v[84:85], v[88:89]
  v_lshlrev_b32 v84, 16, v47
  v_and_b32 v85, 0xffff0000, v47
  v_pk_add_f32 v[84:85], v[84:85], v[86:87] neg_lo:[0,1] neg_hi:[0,1]
  v_pk_fma_f32 v[88:89], v[84:85], v[84:85], v[88:89]
  v_lshlrev_b32 v84, 16, v48
  v_and_b32 v85, 0xffff0000, v48
  v_pk_add_f32 v[84:85], v[84:85], v[86:87] neg_lo:[0,1] neg_hi:[0,1]
  v_pk_fma_f32 v[88:89], v[84:85], v[84:85], v[88:89]
  v_lshlrev_b32 v84, 16, v49
  v_and_b32 v85, 0xffff0000, v49
  v_pk_add_f32 v[84:85], v[84:85], v[86:87] neg_lo:[0,1] neg_hi:[0,1]
  v_pk_fma_f32 v[88:89], v[84:85], v[84:85], v[88:89]
  v_lshlrev_b32 v84, 16, v50
  v_and_b32 v85, 0xffff0000, v50
  v_pk_add_f32 v[84:85], v[84:85], v[86:87] neg_lo:[0,1] neg_hi:[0,1]
  v_pk_fma_f32 v[88:89], v[84:85], v[84:85], v[88:89]
  v_lshlrev_b32 v84, 16, v51
  v_and_b32 v85, 0xffff0000, v51
  v_pk_add_f32 v[84:85], v[84:85], v[86:87] neg_lo:[0,1] neg_hi:[0,1]
  v_pk_fma_f32 v[88:89], v[84:85], v[84:85], v[88:89]
  v_add_f32 v87, v88, v89
  s_nop 1
  v_add_f32_dpp v87, v87, v87 quad_perm:[1,0,3,2] row_mask:0xf bank_mask:0xf
  s_nop 1
  v_add_f32_dpp v87, v87, v87 quad_perm:[2,3,0,1] row_mask:0xf bank_mask:0xf
  s_nop 1
  v_add_f32_dpp v87, v87, v87 row_half_mirror row_mask:0xf bank_mask:0xf
  v_mul_f32 v87, 0x3b000000, v87
  v_cvt_pk_bf16_f32 v236, v86, v86
  v_lshlrev_b32 v236, 16, v236
  v_cvt_pk_bf16_f32 v87, v87, v87
  v_lshlrev_b32 v87, 16, v87
  v_add_f32 v87, 0x3727c5ac, v87
  v_cvt_pk_bf16_f32 v87, v87, v87
  v_lshlrev_b32 v87, 16, v87
  v_sqrt_f32 v87, v87
  s_nop 0
  v_cvt_pk_bf16_f32 v238, v87, v87
  v_lshlrev_b32 v238, 16, v238
  v_rcp_f32 v240, v238
  s_nop 0
  v_mov_b32 v86, 0
  v_mov_b32 v87, 0
  s_mov_b32 s24, 0x3f803f80
  v_lshlrev_b32 v84, 16, v52
  v_and_b32 v85, 0xffff0000, v52
  v_pk_add_f32 v[86:87], v[84:85], v[86:87]
  v_lshlrev_b32 v84, 16, v53
  v_and_b32 v85, 0xffff0000, v53
  v_pk_add_f32 v[86:87], v[84:85], v[86:87]
  v_lshlrev_b32 v84, 16, v54
  v_and_b32 v85, 0xffff0000, v54
  v_pk_add_f32 v[86:87], v[84:85], v[86:87]
  v_lshlrev_b32 v84, 16, v55
  v_and_b32 v85, 0xffff0000, v55
  v_pk_add_f32 v[86:87], v[84:85], v[86:87]
  v_lshlrev_b32 v84, 16, v56
  v_and_b32 v85, 0xffff0000, v56
  v_pk_add_f32 v[86:87], v[84:85], v[86:87]
  v_lshlrev_b32 v84, 16, v57
  v_and_b32 v85, 0xffff0000, v57
  v_pk_add_f32 v[86:87], v[84:85], v[86:87]
  v_lshlrev_b32 v84, 16, v58
  v_and_b32 v85, 0xffff0000, v58
  v_pk_add_f32 v[86:87], v[84:85], v[86:87]
  v_lshlrev_b32 v84, 16, v59
  v_and_b32 v85, 0xffff0000, v59
  v_pk_add_f32 v[86:87], v[84:85], v[86:87]
  v_lshlrev_b32 v84, 16, v60
  v_and_b32 v85, 0xffff0000, v60
  v_pk_add_f32 v[86:87], v[84:85], v[86:87]
  v_lshlrev_b32 v84, 16, v61
  v_and_b32 v85, 0xffff0000, v61
  v_pk_add_f32 v[86:87], v[84:85], v[86:87]
  v_lshlrev_b32 v84, 16, v62
  v_and_b32 v85, 0xffff0000, v62
  v_pk_add_f32 v[86:87], v[84:85], v[86:87]
  v_lshlrev_b32 v84, 16, v63
  v_and_b32 v85, 0xffff0000, v63
  v_pk_add_f32 v[86:87], v[84:85], v[86:87]
  v_lshlrev_b32 v84, 16, v64
  v_and_b32 v85, 0xffff0000, v64
  v_pk_add_f32 v[86:87], v[84:85], v[86:87]
  v_lshlrev_b32 v84, 16, v65
  v_and_b32 v85, 0xffff0000, v65
  v_pk_add_f32 v[86:87], v[84:85], v[86:87]
  v_lshlrev_b32 v84, 16, v66
  v_and_b32 v85, 0xffff0000, v66
  v_pk_add_f32 v[86:87], v[84:85], v[86:87]
  v_lshlrev_b32 v84, 16, v67
  v_and_b32 v85, 0xffff0000, v67
  v_pk_add_f32 v[86:87], v[84:85], v[86:87]
  v_lshlrev_b32 v84, 16, v68
  v_and_b32 v85, 0xffff0000, v68
  v_pk_add_f32 v[86:87], v[84:85], v[86:87]
  v_lshlrev_b32 v84, 16, v69
  v_and_b32 v85, 0xffff0000, v69
  v_pk_add_f32 v[86:87], v[84:85], v[86:87]
  v_lshlrev_b32 v84, 16, v70
  v_and_b32 v85, 0xffff0000, v70
  v_pk_add_f32 v[86:87], v[84:85], v[86:87]
  v_lshlrev_b32 v84, 16, v71
  v_and_b32 v85, 0xffff0000, v71
  v_pk_add_f32 v[86:87], v[84:85], v[86:87]
  v_lshlrev_b32 v84, 16, v72
  v_and_b32 v85, 0xffff0000, v72
  v_pk_add_f32 v[86:87], v[84:85], v[86:87]
  v_lshlrev_b32 v84, 16, v73
  v_and_b32 v85, 0xffff0000, v73
  v_pk_add_f32 v[86:87], v[84:85], v[86:87]
  v_lshlrev_b32 v84, 16, v74
  v_and_b32 v85, 0xffff0000, v74
  v_pk_add_f32 v[86:87], v[84:85], v[86:87]
  v_lshlrev_b32 v84, 16, v75
  v_and_b32 v85, 0xffff0000, v75
  v_pk_add_f32 v[86:87], v[84:85], v[86:87]
  v_lshlrev_b32 v84, 16, v76
  v_and_b32 v85, 0xffff0000, v76
  v_pk_add_f32 v[86:87], v[84:85], v[86:87]
  v_lshlrev_b32 v84, 16, v77
  v_and_b32 v85, 0xffff0000, v77
  v_pk_add_f32 v[86:87], v[84:85], v[86:87]
  v_lshlrev_b32 v84, 16, v78
  v_and_b32 v85, 0xffff0000, v78
  v_pk_add_f32 v[86:87], v[84:85], v[86:87]
  v_lshlrev_b32 v84, 16, v79
  v_and_b32 v85, 0xffff0000, v79
  v_pk_add_f32 v[86:87], v[84:85], v[86:87]
  v_lshlrev_b32 v84, 16, v80
  v_and_b32 v85, 0xffff0000, v80
  v_pk_add_f32 v[86:87], v[84:85], v[86:87]
  v_lshlrev_b32 v84, 16, v81
  v_and_b32 v85, 0xffff0000, v81
  v_pk_add_f32 v[86:87], v[84:85], v[86:87]
  v_lshlrev_b32 v84, 16, v82
  v_and_b32 v85, 0xffff0000, v82
  v_pk_add_f32 v[86:87], v[84:85], v[86:87]
  v_lshlrev_b32 v84, 16, v83
  v_and_b32 v85, 0xffff0000, v83
  v_pk_add_f32 v[86:87], v[84:85], v[86:87]
  v_add_f32 v86, v86, v87
  s_nop 1
  v_add_f32_dpp v86, v86, v86 quad_perm:[1,0,3,2] row_mask:0xf bank_mask:0xf
  s_nop 1
  v_add_f32_dpp v86, v86, v86 quad_perm:[2,3,0,1] row_mask:0xf bank_mask:0xf
  s_nop 1
  v_add_f32_dpp v86, v86, v86 row_half_mirror row_mask:0xf bank_mask:0xf
  v_mul_f32 v86, 0x3b000000, v86
  v_mov_b32 v87, v86
  v_mov_b32 v88, 0
  v_mov_b32 v89, 0
  v_lshlrev_b32 v84, 16, v52
  v_and_b32 v85, 0xffff0000, v52
  v_pk_add_f32 v[84:85], v[84:85], v[86:87] neg_lo:[0,1] neg_hi:[0,1]
  v_pk_fma_f32 v[88:89], v[84:85], v[84:85], v[88:89]
  v_lshlrev_b32 v84, 16, v53
  v_and_b32 v85, 0xffff0000, v53
  v_pk_add_f32 v[84:85], v[84:85], v[86:87] neg_lo:[0,1] neg_hi:[0,1]
  v_pk_fma_f32 v[88:89], v[84:85], v[84:85], v[88:89]
  v_lshlrev_b32 v84, 16, v54
  v_and_b32 v85, 0xffff0000, v54
  v_pk_add_f32 v[84:85], v[84:85], v[86:87] neg_lo:[0,1] neg_hi:[0,1]
  v_pk_fma_f32 v[88:89], v[84:85], v[84:85], v[88:89]
  v_lshlrev_b32 v84, 16, v55
  v_and_b32 v85, 0xffff0000, v55
  v_pk_add_f32 v[84:85], v[84:85], v[86:87] neg_lo:[0,1] neg_hi:[0,1]
  v_pk_fma_f32 v[88:89], v[84:85], v[84:85], v[88:89]
  v_lshlrev_b32 v84, 16, v56
  v_and_b32 v85, 0xffff0000, v56
  v_pk_add_f32 v[84:85], v[84:85], v[86:87] neg_lo:[0,1] neg_hi:[0,1]
  v_pk_fma_f32 v[88:89], v[84:85], v[84:85], v[88:89]
  v_lshlrev_b32 v84, 16, v57
  v_and_b32 v85, 0xffff0000, v57
  v_pk_add_f32 v[84:85], v[84:85], v[86:87] neg_lo:[0,1] neg_hi:[0,1]
  v_pk_fma_f32 v[88:89], v[84:85], v[84:85], v[88:89]
  v_lshlrev_b32 v84, 16, v58
  v_and_b32 v85, 0xffff0000, v58
  v_pk_add_f32 v[84:85], v[84:85], v[86:87] neg_lo:[0,1] neg_hi:[0,1]
  v_pk_fma_f32 v[88:89], v[84:85], v[84:85], v[88:89]
  v_lshlrev_b32 v84, 16, v59
  v_and_b32 v85, 0xffff0000, v59
  v_pk_add_f32 v[84:85], v[84:85], v[86:87] neg_lo:[0,1] neg_hi:[0,1]
  v_pk_fma_f32 v[88:89], v[84:85], v[84:85], v[88:89]
  v_lshlrev_b32 v84, 16, v60
  v_and_b32 v85, 0xffff0000, v60
  v_pk_add_f32 v[84:85], v[84:85], v[86:87] neg_lo:[0,1] neg_hi:[0,1]
  v_pk_fma_f32 v[88:89], v[84:85], v[84:85], v[88:89]
  v_lshlrev_b32 v84, 16, v61
  v_and_b32 v85, 0xffff0000, v61
  v_pk_add_f32 v[84:85], v[84:85], v[86:87] neg_lo:[0,1] neg_hi:[0,1]
  v_pk_fma_f32 v[88:89], v[84:85], v[84:85], v[88:89]
  v_lshlrev_b32 v84, 16, v62
  v_and_b32 v85, 0xffff0000, v62
  v_pk_add_f32 v[84:85], v[84:85], v[86:87] neg_lo:[0,1] neg_hi:[0,1]
  v_pk_fma_f32 v[88:89], v[84:85], v[84:85], v[88:89]
  v_lshlrev_b32 v84, 16, v63
  v_and_b32 v85, 0xffff0000, v63
  v_pk_add_f32 v[84:85], v[84:85], v[86:87] neg_lo:[0,1] neg_hi:[0,1]
  v_pk_fma_f32 v[88:89], v[84:85], v[84:85], v[88:89]
  v_lshlrev_b32 v84, 16, v64
  v_and_b32 v85, 0xffff0000, v64
  v_pk_add_f32 v[84:85], v[84:85], v[86:87] neg_lo:[0,1] neg_hi:[0,1]
  v_pk_fma_f32 v[88:89], v[84:85], v[84:85], v[88:89]
  v_lshlrev_b32 v84, 16, v65
  v_and_b32 v85, 0xffff0000, v65
  v_pk_add_f32 v[84:85], v[84:85], v[86:87] neg_lo:[0,1] neg_hi:[0,1]
  v_pk_fma_f32 v[88:89], v[84:85], v[84:85], v[88:89]
  v_lshlrev_b32 v84, 16, v66
  v_and_b32 v85, 0xffff0000, v66
  v_pk_add_f32 v[84:85], v[84:85], v[86:87] neg_lo:[0,1] neg_hi:[0,1]
  v_pk_fma_f32 v[88:89], v[84:85], v[84:85], v[88:89]
  v_lshlrev_b32 v84, 16, v67
  v_and_b32 v85, 0xffff0000, v67
  v_pk_add_f32 v[84:85], v[84:85], v[86:87] neg_lo:[0,1] neg_hi:[0,1]
  v_pk_fma_f32 v[88:89], v[84:85], v[84:85], v[88:89]
  v_lshlrev_b32 v84, 16, v68
  v_and_b32 v85, 0xffff0000, v68
  v_pk_add_f32 v[84:85], v[84:85], v[86:87] neg_lo:[0,1] neg_hi:[0,1]
  v_pk_fma_f32 v[88:89], v[84:85], v[84:85], v[88:89]
  v_lshlrev_b32 v84, 16, v69
  v_and_b32 v85, 0xffff0000, v69
  v_pk_add_f32 v[84:85], v[84:85], v[86:87] neg_lo:[0,1] neg_hi:[0,1]
  v_pk_fma_f32 v[88:89], v[84:85], v[84:85], v[88:89]
  v_lshlrev_b32 v84, 16, v70
  v_and_b32 v85, 0xffff0000, v70
  v_pk_add_f32 v[84:85], v[84:85], v[86:87] neg_lo:[0,1] neg_hi:[0,1]
  v_pk_fma_f32 v[88:89], v[84:85], v[84:85], v[88:89]
  v_lshlrev_b32 v84, 16, v71
  v_and_b32 v85, 0xffff0000, v71
  v_pk_add_f32 v[84:85], v[84:85], v[86:87] neg_lo:[0,1] neg_hi:[0,1]
  v_pk_fma_f32 v[88:89], v[84:85], v[84:85], v[88:89]
  v_lshlrev_b32 v84, 16, v72
  v_and_b32 v85, 0xffff0000, v72
  v_pk_add_f32 v[84:85], v[84:85], v[86:87] neg_lo:[0,1] neg_hi:[0,1]
  v_pk_fma_f32 v[88:89], v[84:85], v[84:85], v[88:89]
  v_lshlrev_b32 v84, 16, v73
  v_and_b32 v85, 0xffff0000, v73
  v_pk_add_f32 v[84:85], v[84:85], v[86:87] neg_lo:[0,1] neg_hi:[0,1]
  v_pk_fma_f32 v[88:89], v[84:85], v[84:85], v[88:89]
  v_lshlrev_b32 v84, 16, v74
  v_and_b32 v85, 0xffff0000, v74
  v_pk_add_f32 v[84:85], v[84:85], v[86:87] neg_lo:[0,1] neg_hi:[0,1]
  v_pk_fma_f32 v[88:89], v[84:85], v[84:85], v[88:89]
  v_lshlrev_b32 v84, 16, v75
  v_and_b32 v85, 0xffff0000, v75
  v_pk_add_f32 v[84:85], v[84:85], v[86:87] neg_lo:[0,1] neg_hi:[0,1]
  v_pk_fma_f32 v[88:89], v[84:85], v[84:85], v[88:89]
  v_lshlrev_b32 v84, 16, v76
  v_and_b32 v85, 0xffff0000, v76
  v_pk_add_f32 v[84:85], v[84:85], v[86:87] neg_lo:[0,1] neg_hi:[0,1]
  v_pk_fma_f32 v[88:89], v[84:85], v[84:85], v[88:89]
  v_lshlrev_b32 v84, 16, v77
  v_and_b32 v85, 0xffff0000, v77
  v_pk_add_f32 v[84:85], v[84:85], v[86:87] neg_lo:[0,1] neg_hi:[0,1]
  v_pk_fma_f32 v[88:89], v[84:85], v[84:85], v[88:89]
  v_lshlrev_b32 v84, 16, v78
  v_and_b32 v85, 0xffff0000, v78
  v_pk_add_f32 v[84:85], v[84:85], v[86:87] neg_lo:[0,1] neg_hi:[0,1]
  v_pk_fma_f32 v[88:89], v[84:85], v[84:85], v[88:89]
  v_lshlrev_b32 v84, 16, v79
  v_and_b32 v85, 0xffff0000, v79
  v_pk_add_f32 v[84:85], v[84:85], v[86:87] neg_lo:[0,1] neg_hi:[0,1]
  v_pk_fma_f32 v[88:89], v[84:85], v[84:85], v[88:89]
  v_lshlrev_b32 v84, 16, v80
  v_and_b32 v85, 0xffff0000, v80
  v_pk_add_f32 v[84:85], v[84:85], v[86:87] neg_lo:[0,1] neg_hi:[0,1]
  v_pk_fma_f32 v[88:89], v[84:85], v[84:85], v[88:89]
  v_lshlrev_b32 v84, 16, v81
  v_and_b32 v85, 0xffff0000, v81
  v_pk_add_f32 v[84:85], v[84:85], v[86:87] neg_lo:[0,1] neg_hi:[0,1]
  v_pk_fma_f32 v[88:89], v[84:85], v[84:85], v[88:89]
  v_lshlrev_b32 v84, 16, v82
  v_and_b32 v85, 0xffff0000, v82
  v_pk_add_f32 v[84:85], v[84:85], v[86:87] neg_lo:[0,1] neg_hi:[0,1]
  v_pk_fma_f32 v[88:89], v[84:85], v[84:85], v[88:89]
  v_lshlrev_b32 v84, 16, v83
  v_and_b32 v85, 0xffff0000, v83
  v_pk_add_f32 v[84:85], v[84:85], v[86:87] neg_lo:[0,1] neg_hi:[0,1]
  v_pk_fma_f32 v[88:89], v[84:85], v[84:85], v[88:89]
  v_add_f32 v87, v88, v89
  s_nop 1
  v_add_f32_dpp v87, v87, v87 quad_perm:[1,0,3,2] row_mask:0xf bank_mask:0xf
  s_nop 1
  v_add_f32_dpp v87, v87, v87 quad_perm:[2,3,0,1] row_mask:0xf bank_mask:0xf
  s_nop 1
  v_add_f32_dpp v87, v87, v87 row_half_mirror row_mask:0xf bank_mask:0xf
  v_mul_f32 v87, 0x3b000000, v87
  v_cvt_pk_bf16_f32 v237, v86, v86
  v_lshlrev_b32 v237, 16, v237
  v_cvt_pk_bf16_f32 v87, v87, v87
  v_lshlrev_b32 v87, 16, v87
  v_add_f32 v87, 0x3727c5ac, v87
  v_cvt_pk_bf16_f32 v87, v87, v87
  v_lshlrev_b32 v87, 16, v87
  v_sqrt_f32 v87, v87
  s_nop 0
  v_cvt_pk_bf16_f32 v239, v87, v87
  v_lshlrev_b32 v239, 16, v239
  v_rcp_f32 v241, v239
  s_nop 0
  v_mov_b32 v100, 0
  v_mov_b32 v101, 0
  v_mov_b32 v102, 0
  v_mov_b32 v103, 0
  v_mov_b32 v104, 0
  v_mov_b32 v105, 0
  v_mov_b32 v106, 0
  v_mov_b32 v107, 0
  v_mov_b32 v108, 0
  v_mov_b32 v109, 0
  v_mov_b32 v110, 0
  v_mov_b32 v111, 0
  v_mov_b32 v112, 0
  v_mov_b32 v113, 0
  v_mov_b32 v114, 0
  v_mov_b32 v115, 0
  v_mov_b32 v116, 0
  v_mov_b32 v117, 0
  v_mov_b32 v118, 0
  v_mov_b32 v119, 0
  v_mov_b32 v120, 0
  v_mov_b32 v121, 0
  v_mov_b32 v122, 0
  v_mov_b32 v123, 0
  v_mov_b32 v124, 0
  v_mov_b32 v125, 0
  v_mov_b32 v126, 0
  v_mov_b32 v127, 0
  v_mov_b32 v128, 0
  v_mov_b32 v129, 0
  v_mov_b32 v130, 0
  v_mov_b32 v131, 0
  v_mov_b32 v132, 0
  v_mov_b32 v133, 0
  v_mov_b32 v134, 0
  v_mov_b32 v135, 0
  v_mov_b32 v136, 0
  v_mov_b32 v137, 0
  v_mov_b32 v138, 0
  v_mov_b32 v139, 0
  v_mov_b32 v140, 0
  v_mov_b32 v141, 0
  v_mov_b32 v142, 0
  v_mov_b32 v143, 0
  v_mov_b32 v144, 0
  v_mov_b32 v145, 0
  v_mov_b32 v146, 0
  v_mov_b32 v147, 0
  v_mov_b32 v148, 0
  v_mov_b32 v149, 0
  v_mov_b32 v150, 0
  v_mov_b32 v151, 0
  v_mov_b32 v152, 0
  v_mov_b32 v153, 0
  v_mov_b32 v154, 0
  v_mov_b32 v155, 0
  v_mov_b32 v156, 0
  v_mov_b32 v157, 0
  v_mov_b32 v158, 0
  v_mov_b32 v159, 0
  v_mov_b32 v160, 0
  v_mov_b32 v161, 0
  v_mov_b32 v162, 0
  v_mov_b32 v163, 0
  v_mov_b32 v164, 0
  v_mov_b32 v165, 0
  v_mov_b32 v166, 0
  v_mov_b32 v167, 0
  v_mov_b32 v168, 0
  v_mov_b32 v169, 0
  v_mov_b32 v170, 0
  v_mov_b32 v171, 0
  v_mov_b32 v172, 0
  v_mov_b32 v173, 0
  v_mov_b32 v174, 0
  v_mov_b32 v175, 0
  v_mov_b32 v176, 0
  v_mov_b32 v177, 0
  v_mov_b32 v178, 0
  v_mov_b32 v179, 0
  v_lshlrev_b32 v84, 16, v20
  v_and_b32 v85, 0xffff0000, v20
  v_sub_f32 v84, v84, v236
  v_sub_f32 v85, v85, v236
  v_cvt_pk_bf16_f32 v84, v84, v85
  v_and_b32 v85, 0xffff0000, v84
  v_lshlrev_b32 v84, 16, v84
  v_mul_f32 v86, v84, v240
  v_mul_f32 v87, v85, v240
  v_fma_f32 v84, -v86, v238, v84
  v_fma_f32 v85, -v87, v238, v85
  v_fmac_f32 v86, v84, v240
  v_fmac_f32 v87, v85, v240
  v_cvt_pk_bf16_f32 v20, v86, v87
  v_lshlrev_b32 v84, 16, v21
  v_and_b32 v85, 0xffff0000, v21
  v_sub_f32 v84, v84, v236
  v_sub_f32 v85, v85, v236
  v_cvt_pk_bf16_f32 v84, v84, v85
  v_and_b32 v85, 0xffff0000, v84
  v_lshlrev_b32 v84, 16, v84
  v_mul_f32 v86, v84, v240
  v_mul_f32 v87, v85, v240
  v_fma_f32 v84, -v86, v238, v84
  v_fma_f32 v85, -v87, v238, v85
  v_fmac_f32 v86, v84, v240
  v_fmac_f32 v87, v85, v240
  v_cvt_pk_bf16_f32 v21, v86, v87
  v_lshlrev_b32 v84, 16, v22
  v_and_b32 v85, 0xffff0000, v22
  v_sub_f32 v84, v84, v236
  v_sub_f32 v85, v85, v236
  v_cvt_pk_bf16_f32 v84, v84, v85
  v_and_b32 v85, 0xffff0000, v84
  v_lshlrev_b32 v84, 16, v84
  v_mul_f32 v86, v84, v240
  v_mul_f32 v87, v85, v240
  v_fma_f32 v84, -v86, v238, v84
  v_fma_f32 v85, -v87, v238, v85
  v_fmac_f32 v86, v84, v240
  v_fmac_f32 v87, v85, v240
  v_cvt_pk_bf16_f32 v22, v86, v87
  v_lshlrev_b32 v84, 16, v23
  v_and_b32 v85, 0xffff0000, v23
  v_sub_f32 v84, v84, v236
  v_sub_f32 v85, v85, v236
  v_cvt_pk_bf16_f32 v84, v84, v85
  v_and_b32 v85, 0xffff0000, v84
  v_lshlrev_b32 v84, 16, v84
  v_mul_f32 v86, v84, v240
  v_mul_f32 v87, v85, v240
  v_fma_f32 v84, -v86, v238, v84
  v_fma_f32 v85, -v87, v238, v85
  v_fmac_f32 v86, v84, v240
  v_fmac_f32 v87, v85, v240
  v_cvt_pk_bf16_f32 v23, v86, v87
  v_lshlrev_b32 v84, 16, v52
  v_and_b32 v85, 0xffff0000, v52
  v_sub_f32 v84, v84, v237
  v_sub_f32 v85, v85, v237
  v_cvt_pk_bf16_f32 v84, v84, v85
  v_and_b32 v85, 0xffff0000, v84
  v_lshlrev_b32 v84, 16, v84
  v_mul_f32 v86, v84, v241
  v_mul_f32 v87, v85, v241
  v_fma_f32 v84, -v86, v239, v84
  v_fma_f32 v85, -v87, v239, v85
  v_fmac_f32 v86, v84, v241
  v_fmac_f32 v87, v85, v241
  v_cvt_pk_bf16_f32 v52, v86, v87
  v_lshlrev_b32 v84, 16, v53
  v_and_b32 v85, 0xffff0000, v53
  v_sub_f32 v84, v84, v237
  v_sub_f32 v85, v85, v237
  v_cvt_pk_bf16_f32 v84, v84, v85
  v_and_b32 v85, 0xffff0000, v84
  v_lshlrev_b32 v84, 16, v84
  v_mul_f32 v86, v84, v241
  v_mul_f32 v87, v85, v241
  v_fma_f32 v84, -v86, v239, v84
  v_fma_f32 v85, -v87, v239, v85
  v_fmac_f32 v86, v84, v241
  v_fmac_f32 v87, v85, v241
  v_cvt_pk_bf16_f32 v53, v86, v87
  v_lshlrev_b32 v84, 16, v54
  v_and_b32 v85, 0xffff0000, v54
  v_sub_f32 v84, v84, v237
  v_sub_f32 v85, v85, v237
  v_cvt_pk_bf16_f32 v84, v84, v85
  v_and_b32 v85, 0xffff0000, v84
  v_lshlrev_b32 v84, 16, v84
  v_mul_f32 v86, v84, v241
  v_mul_f32 v87, v85, v241
  v_fma_f32 v84, -v86, v239, v84
  v_fma_f32 v85, -v87, v239, v85
  v_fmac_f32 v86, v84, v241
  v_fmac_f32 v87, v85, v241
  v_cvt_pk_bf16_f32 v54, v86, v87
  v_lshlrev_b32 v84, 16, v55
  v_and_b32 v85, 0xffff0000, v55
  v_sub_f32 v84, v84, v237
  v_sub_f32 v85, v85, v237
  v_cvt_pk_bf16_f32 v84, v84, v85
  v_and_b32 v85, 0xffff0000, v84
  v_lshlrev_b32 v84, 16, v84
  v_mul_f32 v86, v84, v241
  v_mul_f32 v87, v85, v241
  v_fma_f32 v84, -v86, v239, v84
  v_fma_f32 v85, -v87, v239, v85
  v_fmac_f32 v86, v84, v241
  v_fmac_f32 v87, v85, v241
  v_cvt_pk_bf16_f32 v55, v86, v87
  ds_write_b128 v244, v[20:23] offset:0
  ds_write_b128 v245, v[52:55] offset:0
  s_waitcnt vmcnt(0) lgkmcnt(0)
  s_barrier
  ds_read_b128 v[180:183], v246 offset:0
  ds_read_b64_tr_b16 v[188:189], v250 offset:0
  ds_read_b64_tr_b16 v[190:191], v250 offset:512
  ds_read_b64_tr_b16 v[192:193], v251 offset:0
  ds_read_b64_tr_b16 v[194:195], v251 offset:512
  ds_read_b64_tr_b16 v[196:197], v252 offset:0
  ds_read_b64_tr_b16 v[198:199], v252 offset:512
  ds_read_b64_tr_b16 v[200:201], v253 offset:0
  ds_read_b64_tr_b16 v[202:203], v253 offset:512
  ds_read_b64_tr_b16 v[204:205], v254 offset:0
  ds_read_b64_tr_b16 v[206:207], v254 offset:512
  ds_read_b128 v[184:187], v247 offset:0
  ds_read_b64_tr_b16 v[208:209], v250 offset:2048
  ds_read_b64_tr_b16 v[210:211], v250 offset:2560
  ds_read_b64_tr_b16 v[212:213], v251 offset:2048
  ds_read_b64_tr_b16 v[214:215], v251 offset:2560
  ds_read_b64_tr_b16 v[216:217], v252 offset:2048
  ds_read_b64_tr_b16 v[218:219], v252 offset:2560
  ds_read_b64_tr_b16 v[220:221], v253 offset:2048
  ds_read_b64_tr_b16 v[222:223], v253 offset:2560
  ds_read_b64_tr_b16 v[224:225], v254 offset:2048
  ds_read_b64_tr_b16 v[226:227], v254 offset:2560
  s_waitcnt lgkmcnt(11)
  v_mfma_f32_32x32x16_bf16 v[100:115], v[188:191], v[180:183], v[100:115]
  v_mfma_f32_32x32x16_bf16 v[116:131], v[192:195], v[180:183], v[116:131]
  v_mfma_f32_32x32x16_bf16 v[132:147], v[196:199], v[180:183], v[132:147]
  v_mfma_f32_32x32x16_bf16 v[148:163], v[200:203], v[180:183], v[148:163]
  v_mfma_f32_32x32x16_bf16 v[164:179], v[204:207], v[180:183], v[164:179]
  ds_read_b128 v[180:183], v248 offset:0
  ds_read_b64_tr_b16 v[188:189], v250 offset:4096
  ds_read_b64_tr_b16 v[190:191], v250 offset:4608
  ds_read_b64_tr_b16 v[192:193], v251 offset:4096
  ds_read_b64_tr_b16 v[194:195], v251 offset:4608
  ds_read_b64_tr_b16 v[196:197], v252 offset:4096
  ds_read_b64_tr_b16 v[198:199], v252 offset:4608
  ds_read_b64_tr_b16 v[200:201], v253 offset:4096
  ds_read_b64_tr_b16 v[202:203], v253 offset:4608
  ds_read_b64_tr_b16 v[204:205], v254 offset:4096
  ds_read_b64_tr_b16 v[206:207], v254 offset:4608
  s_waitcnt lgkmcnt(11)
  v_mfma_f32_32x32x16_bf16 v[100:115], v[208:211], v[184:187], v[100:115]
  v_lshlrev_b32 v84, 16, v24
  v_and_b32 v85, 0xffff0000, v24
  v_sub_f32 v84, v84, v236
  v_sub_f32 v85, v85, v236
  v_cvt_pk_bf16_f32 v84, v84, v85
  v_and_b32 v85, 0xffff0000, v84
  v_lshlrev_b32 v84, 16, v84
  v_mul_f32 v86, v84, v240
  v_mul_f32 v87, v85, v240
  v_fma_f32 v84, -v86, v238, v84
  v_fma_f32 v85, -v87, v238, v85
  v_fmac_f32 v86, v84, v240
  v_fmac_f32 v87, v85, v240
  v_cvt_pk_bf16_f32 v24, v86, v87
  v_lshlrev_b32 v84, 16, v25
  v_and_b32 v85, 0xffff0000, v25
  v_sub_f32 v84, v84, v236
  v_sub_f32 v85, v85, v236
  v_cvt_pk_bf16_f32 v84, v84, v85
  v_and_b32 v85, 0xffff0000, v84
  v_lshlrev_b32 v84, 16, v84
  v_mul_f32 v86, v84, v240
  v_mul_f32 v87, v85, v240
  v_mfma_f32_32x32x16_bf16 v[116:131], v[212:215], v[184:187], v[116:131]
  v_fma_f32 v84, -v86, v238, v84
  v_fma_f32 v85, -v87, v238, v85
  v_fmac_f32 v86, v84, v240
  v_fmac_f32 v87, v85, v240
  v_cvt_pk_bf16_f32 v25, v86, v87
  v_lshlrev_b32 v84, 16, v26
  v_and_b32 v85, 0xffff0000, v26
  v_sub_f32 v84, v84, v236
  v_sub_f32 v85, v85, v236
  v_cvt_pk_bf16_f32 v84, v84, v85
  v_and_b32 v85, 0xffff0000, v84
  v_lshlrev_b32 v84, 16, v84
  v_mul_f32 v86, v84, v240
  v_mul_f32 v87, v85, v240
  v_fma_f32 v84, -v86, v238, v84
  v_fma_f32 v85, -v87, v238, v85
  v_fmac_f32 v86, v84, v240
  v_fmac_f32 v87, v85, v240
  v_cvt_pk_bf16_f32 v26, v86, v87
  v_lshlrev_b32 v84, 16, v27
  v_and_b32 v85, 0xffff0000, v27
  v_sub_f32 v84, v84, v236
  v_sub_f32 v85, v85, v236
  v_mfma_f32_32x32x16_bf16 v[132:147], v[216:219], v[184:187], v[132:147]
  v_cvt_pk_bf16_f32 v84, v84, v85
  v_and_b32 v85, 0xffff0000, v84
  v_lshlrev_b32 v84, 16, v84
  v_mul_f32 v86, v84, v240
  v_mul_f32 v87, v85, v240
  v_fma_f32 v84, -v86, v238, v84
  v_fma_f32 v85, -v87, v238, v85
  v_fmac_f32 v86, v84, v240
  v_fmac_f32 v87, v85, v240
  v_cvt_pk_bf16_f32 v27, v86, v87
  v_lshlrev_b32 v84, 16, v56
  v_and_b32 v85, 0xffff0000, v56
  v_sub_f32 v84, v84, v237
  v_sub_f32 v85, v85, v237
  v_cvt_pk_bf16_f32 v84, v84, v85
  v_and_b32 v85, 0xffff0000, v84
  v_lshlrev_b32 v84, 16, v84
  v_mul_f32 v86, v84, v241
  v_mul_f32 v87, v85, v241
  v_fma_f32 v84, -v86, v239, v84
  v_fma_f32 v85, -v87, v239, v85
  v_fmac_f32 v86, v84, v241
  v_fmac_f32 v87, v85, v241
  v_mfma_f32_32x32x16_bf16 v[148:163], v[220:223], v[184:187], v[148:163]
  v_cvt_pk_bf16_f32 v56, v86, v87
  v_lshlrev_b32 v84, 16, v57
  v_and_b32 v85, 0xffff0000, v57
  v_sub_f32 v84, v84, v237
  v_sub_f32 v85, v85, v237
  v_cvt_pk_bf16_f32 v84, v84, v85
  v_and_b32 v85, 0xffff0000, v84
  v_lshlrev_b32 v84, 16, v84
  v_mul_f32 v86, v84, v241
  v_mul_f32 v87, v85, v241
  v_fma_f32 v84, -v86, v239, v84
  v_fma_f32 v85, -v87, v239, v85
  v_fmac_f32 v86, v84, v241
  v_fmac_f32 v87, v85, v241
  v_cvt_pk_bf16_f32 v57, v86, v87
  v_lshlrev_b32 v84, 16, v58
  v_and_b32 v85, 0xffff0000, v58
  v_sub_f32 v84, v84, v237
  v_sub_f32 v85, v85, v237
  v_cvt_pk_bf16_f32 v84, v84, v85
  v_and_b32 v85, 0xffff0000, v84
  v_lshlrev_b32 v84, 16, v84
  v_mul_f32 v86, v84, v241
  v_mfma_f32_32x32x16_bf16 v[164:179], v[224:227], v[184:187], v[164:179]
  v_mul_f32 v87, v85, v241
  v_fma_f32 v84, -v86, v239, v84
  v_fma_f32 v85, -v87, v239, v85
  v_fmac_f32 v86, v84, v241
  v_fmac_f32 v87, v85, v241
  v_cvt_pk_bf16_f32 v58, v86, v87
  v_lshlrev_b32 v84, 16, v59
  v_and_b32 v85, 0xffff0000, v59
  v_sub_f32 v84, v84, v237
  v_sub_f32 v85, v85, v237
  v_cvt_pk_bf16_f32 v84, v84, v85
  v_and_b32 v85, 0xffff0000, v84
  v_lshlrev_b32 v84, 16, v84
  v_mul_f32 v86, v84, v241
  v_mul_f32 v87, v85, v241
  v_fma_f32 v84, -v86, v239, v84
  v_fma_f32 v85, -v87, v239, v85
  v_fmac_f32 v86, v84, v241
  v_fmac_f32 v87, v85, v241
  v_cvt_pk_bf16_f32 v59, v86, v87
  ds_write_b128 v244, v[24:27] offset:16384
  ds_write_b128 v245, v[56:59] offset:16384
  ds_read_b128 v[184:187], v249 offset:0
  ds_read_b64_tr_b16 v[208:209], v250 offset:6144
  ds_read_b64_tr_b16 v[210:211], v250 offset:6656
  ds_read_b64_tr_b16 v[212:213], v251 offset:6144
  ds_read_b64_tr_b16 v[214:215], v251 offset:6656
  ds_read_b64_tr_b16 v[216:217], v252 offset:6144
  ds_read_b64_tr_b16 v[218:219], v252 offset:6656
  ds_read_b64_tr_b16 v[220:221], v253 offset:6144
  ds_read_b64_tr_b16 v[222:223], v253 offset:6656
  ds_read_b64_tr_b16 v[224:225], v254 offset:6144
  ds_read_b64_tr_b16 v[226:227], v254 offset:6656
  s_waitcnt lgkmcnt(11)
  v_mfma_f32_32x32x16_bf16 v[100:115], v[188:191], v[180:183], v[100:115]
  v_mfma_f32_32x32x16_bf16 v[116:131], v[192:195], v[180:183], v[116:131]
  v_mfma_f32_32x32x16_bf16 v[132:147], v[196:199], v[180:183], v[132:147]
  v_mfma_f32_32x32x16_bf16 v[148:163], v[200:203], v[180:183], v[148:163]
  v_mfma_f32_32x32x16_bf16 v[164:179], v[204:207], v[180:183], v[164:179]
  s_waitcnt vmcnt(0) lgkmcnt(0)
  s_barrier
  s_add_u32 m0, s50, 0
  s_nop 0
  global_load_lds_dwordx4 v[10:11], off
  v_add_co_u32 v10, vcc, s44, v10
  v_addc_co_u32 v11, vcc, 0, v11, vcc
  s_add_u32 m0, s50, 1024
  s_nop 0
  global_load_lds_dwordx4 v[12:13], off
  v_add_co_u32 v12, vcc, s45, v12
  v_addc_co_u32 v13, vcc, 0, v13, vcc
  s_add_u32 m0, s50, 2048
  s_nop 0
  global_load_lds_dwordx4 v[14:15], off
  v_add_co_u32 v14, vcc, s46, v14
  v_addc_co_u32 v15, vcc, 0, v15, vcc
  s_add_u32 m0, s50, 3072
  s_nop 0
  global_load_lds_dwordx4 v[16:17], off
  v_add_co_u32 v16, vcc, s47, v16
  v_addc_co_u32 v17, vcc, 0, v17, vcc
  s_add_u32 m0, s50, 4096
  s_nop 0
  global_load_lds_dwordx4 v[18:19], off
  v_add_co_u32 v18, vcc, s48, v18
  v_addc_co_u32 v19, vcc, 0, v19, vcc
  ds_read_b128 v[180:183], v246 offset:16384
  ds_read_b64_tr_b16 v[188:189], v250 offset:40960
  ds_read_b64_tr_b16 v[190:191], v250 offset:41472
  ds_read_b64_tr_b16 v[192:193], v251 offset:40960
  ds_read_b64_tr_b16 v[194:195], v251 offset:41472
  ds_read_b64_tr_b16 v[196:197], v252 offset:40960
  ds_read_b64_tr_b16 v[198:199], v252 offset:41472
  ds_read_b64_tr_b16 v[200:201], v253 offset:40960
  ds_read_b64_tr_b16 v[202:203], v253 offset:41472
  ds_read_b64_tr_b16 v[204:205], v254 offset:40960
  ds_read_b64_tr_b16 v[206:207], v254 offset:41472
  v_mfma_f32_32x32x16_bf16 v[100:115], v[208:211], v[184:187], v[100:115]
  v_mfma_f32_32x32x16_bf16 v[116:131], v[212:215], v[184:187], v[116:131]
  v_mfma_f32_32x32x16_bf16 v[132:147], v[216:219], v[184:187], v[132:147]
  v_mfma_f32_32x32x16_bf16 v[148:163], v[220:223], v[184:187], v[148:163]
  v_mfma_f32_32x32x16_bf16 v[164:179], v[224:227], v[184:187], v[164:179]
  ds_read_b128 v[184:187], v247 offset:16384
  ds_read_b64_tr_b16 v[208:209], v250 offset:43008
  ds_read_b64_tr_b16 v[210:211], v250 offset:43520
  ds_read_b64_tr_b16 v[212:213], v251 offset:43008
  ds_read_b64_tr_b16 v[214:215], v251 offset:43520
  ds_read_b64_tr_b16 v[216:217], v252 offset:43008
  ds_read_b64_tr_b16 v[218:219], v252 offset:43520
  ds_read_b64_tr_b16 v[220:221], v253 offset:43008
  ds_read_b64_tr_b16 v[222:223], v253 offset:43520
  ds_read_b64_tr_b16 v[224:225], v254 offset:43008
  ds_read_b64_tr_b16 v[226:227], v254 offset:43520
  s_waitcnt lgkmcnt(11)
  v_mfma_f32_32x32x16_bf16 v[100:115], v[188:191], v[180:183], v[100:115]
  v_mfma_f32_32x32x16_bf16 v[116:131], v[192:195], v[180:183], v[116:131]
  v_mfma_f32_32x32x16_bf16 v[132:147], v[196:199], v[180:183], v[132:147]
  v_mfma_f32_32x32x16_bf16 v[148:163], v[200:203], v[180:183], v[148:163]
  v_mfma_f32_32x32x16_bf16 v[164:179], v[204:207], v[180:183], v[164:179]
  ds_read_b128 v[180:183], v248 offset:16384
  ds_read_b64_tr_b16 v[188:189], v250 offset:45056
  ds_read_b64_tr_b16 v[190:191], v250 offset:45568
  ds_read_b64_tr_b16 v[192:193], v251 offset:45056
  ds_read_b64_tr_b16 v[194:195], v251 offset:45568
  ds_read_b64_tr_b16 v[196:197], v252 offset:45056
  ds_read_b64_tr_b16 v[198:199], v252 offset:45568
  ds_read_b64_tr_b16 v[200:201], v253 offset:45056
  ds_read_b64_tr_b16 v[202:203], v253 offset:45568
  ds_read_b64_tr_b16 v[204:205], v254 offset:45056
  ds_read_b64_tr_b16 v[206:207], v254 offset:45568
  s_waitcnt lgkmcnt(11)
  v_mfma_f32_32x32x16_bf16 v[100:115], v[208:211], v[184:187], v[100:115]
  v_lshlrev_b32 v84, 16, v28
  v_and_b32 v85, 0xffff0000, v28
  v_sub_f32 v84, v84, v236
  v_sub_f32 v85, v85, v236
  v_cvt_pk_bf16_f32 v84, v84, v85
  v_and_b32 v85, 0xffff0000, v84
  v_lshlrev_b32 v84, 16, v84
  v_mul_f32 v86, v84, v240
  v_mul_f32 v87, v85, v240
  v_fma_f32 v84, -v86, v238, v84
  v_fma_f32 v85, -v87, v238, v85
  v_fmac_f32 v86, v84, v240
  v_fmac_f32 v87, v85, v240
  v_cvt_pk_bf16_f32 v28, v86, v87
  v_lshlrev_b32 v84, 16, v29
  v_and_b32 v85, 0xffff0000, v29
  v_sub_f32 v84, v84, v236
  v_sub_f32 v85, v85, v236
  v_cvt_pk_bf16_f32 v84, v84, v85
  v_and_b32 v85, 0xffff0000, v84
  v_lshlrev_b32 v84, 16, v84
  v_mul_f32 v86, v84, v240
  v_mul_f32 v87, v85, v240
  v_mfma_f32_32x32x16_bf16 v[116:131], v[212:215], v[184:187], v[116:131]
  v_fma_f32 v84, -v86, v238, v84
  v_fma_f32 v85, -v87, v238, v85
  v_fmac_f32 v86, v84, v240
  v_fmac_f32 v87, v85, v240
  v_cvt_pk_bf16_f32 v29, v86, v87
  v_lshlrev_b32 v84, 16, v30
  v_and_b32 v85, 0xffff0000, v30
  v_sub_f32 v84, v84, v236
  v_sub_f32 v85, v85, v236
  v_cvt_pk_bf16_f32 v84, v84, v85
  v_and_b32 v85, 0xffff0000, v84
  v_lshlrev_b32 v84, 16, v84
  v_mul_f32 v86, v84, v240
  v_mul_f32 v87, v85, v240
  v_fma_f32 v84, -v86, v238, v84
  v_fma_f32 v85, -v87, v238, v85
  v_fmac_f32 v86, v84, v240
  v_fmac_f32 v87, v85, v240
  v_cvt_pk_bf16_f32 v30, v86, v87
  v_lshlrev_b32 v84, 16, v31
  v_and_b32 v85, 0xffff0000, v31
  v_sub_f32 v84, v84, v236
  v_sub_f32 v85, v85, v236
  v_mfma_f32_32x32x16_bf16 v[132:147], v[216:219], v[184:187], v[132:147]
  v_cvt_pk_bf16_f32 v84, v84, v85
  v_and_b32 v85, 0xffff0000, v84
  v_lshlrev_b32 v84, 16, v84
  v_mul_f32 v86, v84, v240
  v_mul_f32 v87, v85, v240
  v_fma_f32 v84, -v86, v238, v84
  v_fma_f32 v85, -v87, v238, v85
  v_fmac_f32 v86, v84, v240
  v_fmac_f32 v87, v85, v240
  v_cvt_pk_bf16_f32 v31, v86, v87
  v_lshlrev_b32 v84, 16, v60
  v_and_b32 v85, 0xffff0000, v60
  v_sub_f32 v84, v84, v237
  v_sub_f32 v85, v85, v237
  v_cvt_pk_bf16_f32 v84, v84, v85
  v_and_b32 v85, 0xffff0000, v84
  v_lshlrev_b32 v84, 16, v84
  v_mul_f32 v86, v84, v241
  v_mul_f32 v87, v85, v241
  v_fma_f32 v84, -v86, v239, v84
  v_fma_f32 v85, -v87, v239, v85
  v_fmac_f32 v86, v84, v241
  v_fmac_f32 v87, v85, v241
  v_mfma_f32_32x32x16_bf16 v[148:163], v[220:223], v[184:187], v[148:163]
  v_cvt_pk_bf16_f32 v60, v86, v87
  v_lshlrev_b32 v84, 16, v61
  v_and_b32 v85, 0xffff0000, v61
  v_sub_f32 v84, v84, v237
  v_sub_f32 v85, v85, v237
  v_cvt_pk_bf16_f32 v84, v84, v85
  v_and_b32 v85, 0xffff0000, v84
  v_lshlrev_b32 v84, 16, v84
  v_mul_f32 v86, v84, v241
  v_mul_f32 v87, v85, v241
  v_fma_f32 v84, -v86, v239, v84
  v_fma_f32 v85, -v87, v239, v85
  v_fmac_f32 v86, v84, v241
  v_fmac_f32 v87, v85, v241
  v_cvt_pk_bf16_f32 v61, v86, v87
  v_lshlrev_b32 v84, 16, v62
  v_and_b32 v85, 0xffff0000, v62
  v_sub_f32 v84, v84, v237
  v_sub_f32 v85, v85, v237
  v_cvt_pk_bf16_f32 v84, v84, v85
  v_and_b32 v85, 0xffff0000, v84
  v_lshlrev_b32 v84, 16, v84
  v_mul_f32 v86, v84, v241
  v_mfma_f32_32x32x16_bf16 v[164:179], v[224:227], v[184:187], v[164:179]
  v_mul_f32 v87, v85, v241
  v_fma_f32 v84, -v86, v239, v84
  v_fma_f32 v85, -v87, v239, v85
  v_fmac_f32 v86, v84, v241
  v_fmac_f32 v87, v85, v241
  v_cvt_pk_bf16_f32 v62, v86, v87
  v_lshlrev_b32 v84, 16, v63
  v_and_b32 v85, 0xffff0000, v63
  v_sub_f32 v84, v84, v237
  v_sub_f32 v85, v85, v237
  v_cvt_pk_bf16_f32 v84, v84, v85
  v_and_b32 v85, 0xffff0000, v84
  v_lshlrev_b32 v84, 16, v84
  v_mul_f32 v86, v84, v241
  v_mul_f32 v87, v85, v241
  v_fma_f32 v84, -v86, v239, v84
  v_fma_f32 v85, -v87, v239, v85
  v_fmac_f32 v86, v84, v241
  v_fmac_f32 v87, v85, v241
  v_cvt_pk_bf16_f32 v63, v86, v87
  ds_write_b128 v244, v[28:31] offset:0
  ds_write_b128 v245, v[60:63] offset:0
  ds_read_b128 v[184:187], v249 offset:16384
  ds_read_b64_tr_b16 v[208:209], v250 offset:47104
  ds_read_b64_tr_b16 v[210:211], v250 offset:47616
  ds_read_b64_tr_b16 v[212:213], v251 offset:47104
  ds_read_b64_tr_b16 v[214:215], v251 offset:47616
  ds_read_b64_tr_b16 v[216:217], v252 offset:47104
  ds_read_b64_tr_b16 v[218:219], v252 offset:47616
  ds_read_b64_tr_b16 v[220:221], v253 offset:47104
  ds_read_b64_tr_b16 v[222:223], v253 offset:47616
  ds_read_b64_tr_b16 v[224:225], v254 offset:47104
  ds_read_b64_tr_b16 v[226:227], v254 offset:47616
  s_waitcnt lgkmcnt(11)
  v_mfma_f32_32x32x16_bf16 v[100:115], v[188:191], v[180:183], v[100:115]
  v_mfma_f32_32x32x16_bf16 v[116:131], v[192:195], v[180:183], v[116:131]
  v_mfma_f32_32x32x16_bf16 v[132:147], v[196:199], v[180:183], v[132:147]
  v_mfma_f32_32x32x16_bf16 v[148:163], v[200:203], v[180:183], v[148:163]
  v_mfma_f32_32x32x16_bf16 v[164:179], v[204:207], v[180:183], v[164:179]
  s_waitcnt vmcnt(0) lgkmcnt(0)
  s_barrier
  s_add_u32 m0, s50, 40960
  s_nop 0
  global_load_lds_dwordx4 v[10:11], off
  v_add_co_u32 v10, vcc, s44, v10
  v_addc_co_u32 v11, vcc, 0, v11, vcc
  s_add_u32 m0, s50, 41984
  s_nop 0
  global_load_lds_dwordx4 v[12:13], off
  v_add_co_u32 v12, vcc, s45, v12
  v_addc_co_u32 v13, vcc, 0, v13, vcc
  s_add_u32 m0, s50, 43008
  s_nop 0
  global_load_lds_dwordx4 v[14:15], off
  v_add_co_u32 v14, vcc, s46, v14
  v_addc_co_u32 v15, vcc, 0, v15, vcc
  s_add_u32 m0, s50, 44032
  s_nop 0
  global_load_lds_dwordx4 v[16:17], off
  v_add_co_u32 v16, vcc, s47, v16
  v_addc_co_u32 v17, vcc, 0, v17, vcc
  s_add_u32 m0, s50, 45056
  s_nop 0
  global_load_lds_dwordx4 v[18:19], off
  v_add_co_u32 v18, vcc, s48, v18
  v_addc_co_u32 v19, vcc, 0, v19, vcc
  ds_read_b128 v[180:183], v246 offset:0
  ds_read_b64_tr_b16 v[188:189], v250 offset:0
  ds_read_b64_tr_b16 v[190:191], v250 offset:512
  ds_read_b64_tr_b16 v[192:193], v251 offset:0
  ds_read_b64_tr_b16 v[194:195], v251 offset:512
  ds_read_b64_tr_b16 v[196:197], v252 offset:0
  ds_read_b64_tr_b16 v[198:199], v252 offset:512
  ds_read_b64_tr_b16 v[200:201], v253 offset:0
  ds_read_b64_tr_b16 v[202:203], v253 offset:512
  ds_read_b64_tr_b16 v[204:205], v254 offset:0
  ds_read_b64_tr_b16 v[206:207], v254 offset:512
  v_mfma_f32_32x32x16_bf16 v[100:115], v[208:211], v[184:187], v[100:115]
  v_mfma_f32_32x32x16_bf16 v[116:131], v[212:215], v[184:187], v[116:131]
  v_mfma_f32_32x32x16_bf16 v[132:147], v[216:219], v[184:187], v[132:147]
  v_mfma_f32_32x32x16_bf16 v[148:163], v[220:223], v[184:187], v[148:163]
  v_mfma_f32_32x32x16_bf16 v[164:179], v[224:227], v[184:187], v[164:179]
  ds_read_b128 v[184:187], v247 offset:0
  ds_read_b64_tr_b16 v[208:209], v250 offset:2048
  ds_read_b64_tr_b16 v[210:211], v250 offset:2560
  ds_read_b64_tr_b16 v[212:213], v251 offset:2048
  ds_read_b64_tr_b16 v[214:215], v251 offset:2560
  ds_read_b64_tr_b16 v[216:217], v252 offset:2048
  ds_read_b64_tr_b16 v[218:219], v252 offset:2560
  ds_read_b64_tr_b16 v[220:221], v253 offset:2048
  ds_read_b64_tr_b16 v[222:223], v253 offset:2560
  ds_read_b64_tr_b16 v[224:225], v254 offset:2048
  ds_read_b64_tr_b16 v[226:227], v254 offset:2560
  s_waitcnt lgkmcnt(11)
  v_mfma_f32_32x32x16_bf16 v[100:115], v[188:191], v[180:183], v[100:115]
  v_mfma_f32_32x32x16_bf16 v[116:131], v[192:195], v[180:183], v[116:131]
  v_mfma_f32_32x32x16_bf16 v[132:147], v[196:199], v[180:183], v[132:147]
  v_mfma_f32_32x32x16_bf16 v[148:163], v[200:203], v[180:183], v[148:163]
  v_mfma_f32_32x32x16_bf16 v[164:179], v[204:207], v[180:183], v[164:179]
  ds_read_b128 v[180:183], v248 offset:0
  ds_read_b64_tr_b16 v[188:189], v250 offset:4096
  ds_read_b64_tr_b16 v[190:191], v250 offset:4608
  ds_read_b64_tr_b16 v[192:193], v251 offset:4096
  ds_read_b64_tr_b16 v[194:195], v251 offset:4608
  ds_read_b64_tr_b16 v[196:197], v252 offset:4096
  ds_read_b64_tr_b16 v[198:199], v252 offset:4608
  ds_read_b64_tr_b16 v[200:201], v253 offset:4096
  ds_read_b64_tr_b16 v[202:203], v253 offset:4608
  ds_read_b64_tr_b16 v[204:205], v254 offset:4096
  ds_read_b64_tr_b16 v[206:207], v254 offset:4608
  s_waitcnt lgkmcnt(11)
  v_mfma_f32_32x32x16_bf16 v[100:115], v[208:211], v[184:187], v[100:115]
  v_lshlrev_b32 v84, 16, v32
  v_and_b32 v85, 0xffff0000, v32
  v_sub_f32 v84, v84, v236
  v_sub_f32 v85, v85, v236
  v_cvt_pk_bf16_f32 v84, v84, v85
  v_and_b32 v85, 0xffff0000, v84
  v_lshlrev_b32 v84, 16, v84
  v_mul_f32 v86, v84, v240
  v_mul_f32 v87, v85, v240
  v_fma_f32 v84, -v86, v238, v84
  v_fma_f32 v85, -v87, v238, v85
  v_fmac_f32 v86, v84, v240
  v_fmac_f32 v87, v85, v240
  v_cvt_pk_bf16_f32 v32, v86, v87
  v_lshlrev_b32 v84, 16, v33
  v_and_b32 v85, 0xffff0000, v33
  v_sub_f32 v84, v84, v236
  v_sub_f32 v85, v85, v236
  v_cvt_pk_bf16_f32 v84, v84, v85
  v_and_b32 v85, 0xffff0000, v84
  v_lshlrev_b32 v84, 16, v84
  v_mul_f32 v86, v84, v240
  v_mul_f32 v87, v85, v240
  v_mfma_f32_32x32x16_bf16 v[116:131], v[212:215], v[184:187], v[116:131]
  v_fma_f32 v84, -v86, v238, v84
  v_fma_f32 v85, -v87, v238, v85
  v_fmac_f32 v86, v84, v240
  v_fmac_f32 v87, v85, v240
  v_cvt_pk_bf16_f32 v33, v86, v87
  v_lshlrev_b32 v84, 16, v34
  v_and_b32 v85, 0xffff0000, v34
  v_sub_f32 v84, v84, v236
  v_sub_f32 v85, v85, v236
  v_cvt_pk_bf16_f32 v84, v84, v85
  v_and_b32 v85, 0xffff0000, v84
  v_lshlrev_b32 v84, 16, v84
  v_mul_f32 v86, v84, v240
  v_mul_f32 v87, v85, v240
  v_fma_f32 v84, -v86, v238, v84
  v_fma_f32 v85, -v87, v238, v85
  v_fmac_f32 v86, v84, v240
  v_fmac_f32 v87, v85, v240
  v_cvt_pk_bf16_f32 v34, v86, v87
  v_lshlrev_b32 v84, 16, v35
  v_and_b32 v85, 0xffff0000, v35
  v_sub_f32 v84, v84, v236
  v_sub_f32 v85, v85, v236
  v_mfma_f32_32x32x16_bf16 v[132:147], v[216:219], v[184:187], v[132:147]
  v_cvt_pk_bf16_f32 v84, v84, v85
  v_and_b32 v85, 0xffff0000, v84
  v_lshlrev_b32 v84, 16, v84
  v_mul_f32 v86, v84, v240
  v_mul_f32 v87, v85, v240
  v_fma_f32 v84, -v86, v238, v84
  v_fma_f32 v85, -v87, v238, v85
  v_fmac_f32 v86, v84, v240
  v_fmac_f32 v87, v85, v240
  v_cvt_pk_bf16_f32 v35, v86, v87
  v_lshlrev_b32 v84, 16, v64
  v_and_b32 v85, 0xffff0000, v64
  v_sub_f32 v84, v84, v237
  v_sub_f32 v85, v85, v237
  v_cvt_pk_bf16_f32 v84, v84, v85
  v_and_b32 v85, 0xffff0000, v84
  v_lshlrev_b32 v84, 16, v84
  v_mul_f32 v86, v84, v241
  v_mul_f32 v87, v85, v241
  v_fma_f32 v84, -v86, v239, v84
  v_fma_f32 v85, -v87, v239, v85
  v_fmac_f32 v86, v84, v241
  v_fmac_f32 v87, v85, v241
  v_mfma_f32_32x32x16_bf16 v[148:163], v[220:223], v[184:187], v[148:163]
  v_cvt_pk_bf16_f32 v64, v86, v87
  v_lshlrev_b32 v84, 16, v65
  v_and_b32 v85, 0xffff0000, v65
  v_sub_f32 v84, v84, v237
  v_sub_f32 v85, v85, v237
  v_cvt_pk_bf16_f32 v84, v84, v85
  v_and_b32 v85, 0xffff0000, v84
  v_lshlrev_b32 v84, 16, v84
  v_mul_f32 v86, v84, v241
  v_mul_f32 v87, v85, v241
  v_fma_f32 v84, -v86, v239, v84
  v_fma_f32 v85, -v87, v239, v85
  v_fmac_f32 v86, v84, v241
  v_fmac_f32 v87, v85, v241
  v_cvt_pk_bf16_f32 v65, v86, v87
  v_lshlrev_b32 v84, 16, v66
  v_and_b32 v85, 0xffff0000, v66
  v_sub_f32 v84, v84, v237
  v_sub_f32 v85, v85, v237
  v_cvt_pk_bf16_f32 v84, v84, v85
  v_and_b32 v85, 0xffff0000, v84
  v_lshlrev_b32 v84, 16, v84
  v_mul_f32 v86, v84, v241
  v_mfma_f32_32x32x16_bf16 v[164:179], v[224:227], v[184:187], v[164:179]
  v_mul_f32 v87, v85, v241
  v_fma_f32 v84, -v86, v239, v84
  v_fma_f32 v85, -v87, v239, v85
  v_fmac_f32 v86, v84, v241
  v_fmac_f32 v87, v85, v241
  v_cvt_pk_bf16_f32 v66, v86, v87
  v_lshlrev_b32 v84, 16, v67
  v_and_b32 v85, 0xffff0000, v67
  v_sub_f32 v84, v84, v237
  v_sub_f32 v85, v85, v237
  v_cvt_pk_bf16_f32 v84, v84, v85
  v_and_b32 v85, 0xffff0000, v84
  v_lshlrev_b32 v84, 16, v84
  v_mul_f32 v86, v84, v241
  v_mul_f32 v87, v85, v241
  v_fma_f32 v84, -v86, v239, v84
  v_fma_f32 v85, -v87, v239, v85
  v_fmac_f32 v86, v84, v241
  v_fmac_f32 v87, v85, v241
  v_cvt_pk_bf16_f32 v67, v86, v87
  ds_write_b128 v244, v[32:35] offset:16384
  ds_write_b128 v245, v[64:67] offset:16384
  ds_read_b128 v[184:187], v249 offset:0
  ds_read_b64_tr_b16 v[208:209], v250 offset:6144
  ds_read_b64_tr_b16 v[210:211], v250 offset:6656
  ds_read_b64_tr_b16 v[212:213], v251 offset:6144
  ds_read_b64_tr_b16 v[214:215], v251 offset:6656
  ds_read_b64_tr_b16 v[216:217], v252 offset:6144
  ds_read_b64_tr_b16 v[218:219], v252 offset:6656
  ds_read_b64_tr_b16 v[220:221], v253 offset:6144
  ds_read_b64_tr_b16 v[222:223], v253 offset:6656
  ds_read_b64_tr_b16 v[224:225], v254 offset:6144
  ds_read_b64_tr_b16 v[226:227], v254 offset:6656
  s_waitcnt lgkmcnt(11)
  v_mfma_f32_32x32x16_bf16 v[100:115], v[188:191], v[180:183], v[100:115]
  v_mfma_f32_32x32x16_bf16 v[116:131], v[192:195], v[180:183], v[116:131]
  v_mfma_f32_32x32x16_bf16 v[132:147], v[196:199], v[180:183], v[132:147]
  v_mfma_f32_32x32x16_bf16 v[148:163], v[200:203], v[180:183], v[148:163]
  v_mfma_f32_32x32x16_bf16 v[164:179], v[204:207], v[180:183], v[164:179]
  s_waitcnt vmcnt(0) lgkmcnt(0)
  s_barrier
  s_add_u32 m0, s50, 0
  s_nop 0
  global_load_lds_dwordx4 v[10:11], off
  v_add_co_u32 v10, vcc, s44, v10
  v_addc_co_u32 v11, vcc, 0, v11, vcc
  s_add_u32 m0, s50, 1024
  s_nop 0
  global_load_lds_dwordx4 v[12:13], off
  v_add_co_u32 v12, vcc, s45, v12
  v_addc_co_u32 v13, vcc, 0, v13, vcc
  s_add_u32 m0, s50, 2048
  s_nop 0
  global_load_lds_dwordx4 v[14:15], off
  v_add_co_u32 v14, vcc, s46, v14
  v_addc_co_u32 v15, vcc, 0, v15, vcc
  s_add_u32 m0, s50, 3072
  s_nop 0
  global_load_lds_dwordx4 v[16:17], off
  v_add_co_u32 v16, vcc, s47, v16
  v_addc_co_u32 v17, vcc, 0, v17, vcc
  s_add_u32 m0, s50, 4096
  s_nop 0
  global_load_lds_dwordx4 v[18:19], off
  v_add_co_u32 v18, vcc, s48, v18
  v_addc_co_u32 v19, vcc, 0, v19, vcc
  ds_read_b128 v[180:183], v246 offset:16384
  ds_read_b64_tr_b16 v[188:189], v250 offset:40960
  ds_read_b64_tr_b16 v[190:191], v250 offset:41472
  ds_read_b64_tr_b16 v[192:193], v251 offset:40960
  ds_read_b64_tr_b16 v[194:195], v251 offset:41472
  ds_read_b64_tr_b16 v[196:197], v252 offset:40960
  ds_read_b64_tr_b16 v[198:199], v252 offset:41472
  ds_read_b64_tr_b16 v[200:201], v253 offset:40960
  ds_read_b64_tr_b16 v[202:203], v253 offset:41472
  ds_read_b64_tr_b16 v[204:205], v254 offset:40960
  ds_read_b64_tr_b16 v[206:207], v254 offset:41472
  v_mfma_f32_32x32x16_bf16 v[100:115], v[208:211], v[184:187], v[100:115]
  v_mfma_f32_32x32x16_bf16 v[116:131], v[212:215], v[184:187], v[116:131]
  v_mfma_f32_32x32x16_bf16 v[132:147], v[216:219], v[184:187], v[132:147]
  v_mfma_f32_32x32x16_bf16 v[148:163], v[220:223], v[184:187], v[148:163]
  v_mfma_f32_32x32x16_bf16 v[164:179], v[224:227], v[184:187], v[164:179]
  ds_read_b128 v[184:187], v247 offset:16384
  ds_read_b64_tr_b16 v[208:209], v250 offset:43008
  ds_read_b64_tr_b16 v[210:211], v250 offset:43520
  ds_read_b64_tr_b16 v[212:213], v251 offset:43008
  ds_read_b64_tr_b16 v[214:215], v251 offset:43520
  ds_read_b64_tr_b16 v[216:217], v252 offset:43008
  ds_read_b64_tr_b16 v[218:219], v252 offset:43520
  ds_read_b64_tr_b16 v[220:221], v253 offset:43008
  ds_read_b64_tr_b16 v[222:223], v253 offset:43520
  ds_read_b64_tr_b16 v[224:225], v254 offset:43008
  ds_read_b64_tr_b16 v[226:227], v254 offset:43520
  s_waitcnt lgkmcnt(11)
  v_mfma_f32_32x32x16_bf16 v[100:115], v[188:191], v[180:183], v[100:115]
  v_mfma_f32_32x32x16_bf16 v[116:131], v[192:195], v[180:183], v[116:131]
  v_mfma_f32_32x32x16_bf16 v[132:147], v[196:199], v[180:183], v[132:147]
  v_mfma_f32_32x32x16_bf16 v[148:163], v[200:203], v[180:183], v[148:163]
  v_mfma_f32_32x32x16_bf16 v[164:179], v[204:207], v[180:183], v[164:179]
  ds_read_b128 v[180:183], v248 offset:16384
  ds_read_b64_tr_b16 v[188:189], v250 offset:45056
  ds_read_b64_tr_b16 v[190:191], v250 offset:45568
  ds_read_b64_tr_b16 v[192:193], v251 offset:45056
  ds_read_b64_tr_b16 v[194:195], v251 offset:45568
  ds_read_b64_tr_b16 v[196:197], v252 offset:45056
  ds_read_b64_tr_b16 v[198:199], v252 offset:45568
  ds_read_b64_tr_b16 v[200:201], v253 offset:45056
  ds_read_b64_tr_b16 v[202:203], v253 offset:45568
  ds_read_b64_tr_b16 v[204:205], v254 offset:45056
  ds_read_b64_tr_b16 v[206:207], v254 offset:45568
  s_waitcnt lgkmcnt(11)
  v_mfma_f32_32x32x16_bf16 v[100:115], v[208:211], v[184:187], v[100:115]
  v_lshlrev_b32 v84, 16, v36
  v_and_b32 v85, 0xffff0000, v36
  v_sub_f32 v84, v84, v236
  v_sub_f32 v85, v85, v236
  v_cvt_pk_bf16_f32 v84, v84, v85
  v_and_b32 v85, 0xffff0000, v84
  v_lshlrev_b32 v84, 16, v84
  v_mul_f32 v86, v84, v240
  v_mul_f32 v87, v85, v240
  v_fma_f32 v84, -v86, v238, v84
  v_fma_f32 v85, -v87, v238, v85
  v_fmac_f32 v86, v84, v240
  v_fmac_f32 v87, v85, v240
  v_cvt_pk_bf16_f32 v36, v86, v87
  v_lshlrev_b32 v84, 16, v37
  v_and_b32 v85, 0xffff0000, v37
  v_sub_f32 v84, v84, v236
  v_sub_f32 v85, v85, v236
  v_cvt_pk_bf16_f32 v84, v84, v85
  v_and_b32 v85, 0xffff0000, v84
  v_lshlrev_b32 v84, 16, v84
  v_mul_f32 v86, v84, v240
  v_mul_f32 v87, v85, v240
  v_mfma_f32_32x32x16_bf16 v[116:131], v[212:215], v[184:187], v[116:131]
  v_fma_f32 v84, -v86, v238, v84
  v_fma_f32 v85, -v87, v238, v85
  v_fmac_f32 v86, v84, v240
  v_fmac_f32 v87, v85, v240
  v_cvt_pk_bf16_f32 v37, v86, v87
  v_lshlrev_b32 v84, 16, v38
  v_and_b32 v85, 0xffff0000, v38
  v_sub_f32 v84, v84, v236
  v_sub_f32 v85, v85, v236
  v_cvt_pk_bf16_f32 v84, v84, v85
  v_and_b32 v85, 0xffff0000, v84
  v_lshlrev_b32 v84, 16, v84
  v_mul_f32 v86, v84, v240
  v_mul_f32 v87, v85, v240
  v_fma_f32 v84, -v86, v238, v84
  v_fma_f32 v85, -v87, v238, v85
  v_fmac_f32 v86, v84, v240
  v_fmac_f32 v87, v85, v240
  v_cvt_pk_bf16_f32 v38, v86, v87
  v_lshlrev_b32 v84, 16, v39
  v_and_b32 v85, 0xffff0000, v39
  v_sub_f32 v84, v84, v236
  v_sub_f32 v85, v85, v236
  v_mfma_f32_32x32x16_bf16 v[132:147], v[216:219], v[184:187], v[132:147]
  v_cvt_pk_bf16_f32 v84, v84, v85
  v_and_b32 v85, 0xffff0000, v84
  v_lshlrev_b32 v84, 16, v84
  v_mul_f32 v86, v84, v240
  v_mul_f32 v87, v85, v240
  v_fma_f32 v84, -v86, v238, v84
  v_fma_f32 v85, -v87, v238, v85
  v_fmac_f32 v86, v84, v240
  v_fmac_f32 v87, v85, v240
  v_cvt_pk_bf16_f32 v39, v86, v87
  v_lshlrev_b32 v84, 16, v68
  v_and_b32 v85, 0xffff0000, v68
  v_sub_f32 v84, v84, v237
  v_sub_f32 v85, v85, v237
  v_cvt_pk_bf16_f32 v84, v84, v85
  v_and_b32 v85, 0xffff0000, v84
  v_lshlrev_b32 v84, 16, v84
  v_mul_f32 v86, v84, v241
  v_mul_f32 v87, v85, v241
  v_fma_f32 v84, -v86, v239, v84
  v_fma_f32 v85, -v87, v239, v85
  v_fmac_f32 v86, v84, v241
  v_fmac_f32 v87, v85, v241
  v_mfma_f32_32x32x16_bf16 v[148:163], v[220:223], v[184:187], v[148:163]
  v_cvt_pk_bf16_f32 v68, v86, v87
  v_lshlrev_b32 v84, 16, v69
  v_and_b32 v85, 0xffff0000, v69
  v_sub_f32 v84, v84, v237
  v_sub_f32 v85, v85, v237
  v_cvt_pk_bf16_f32 v84, v84, v85
  v_and_b32 v85, 0xffff0000, v84
  v_lshlrev_b32 v84, 16, v84
  v_mul_f32 v86, v84, v241
  v_mul_f32 v87, v85, v241
  v_fma_f32 v84, -v86, v239, v84
  v_fma_f32 v85, -v87, v239, v85
  v_fmac_f32 v86, v84, v241
  v_fmac_f32 v87, v85, v241
  v_cvt_pk_bf16_f32 v69, v86, v87
  v_lshlrev_b32 v84, 16, v70
  v_and_b32 v85, 0xffff0000, v70
  v_sub_f32 v84, v84, v237
  v_sub_f32 v85, v85, v237
  v_cvt_pk_bf16_f32 v84, v84, v85
  v_and_b32 v85, 0xffff0000, v84
  v_lshlrev_b32 v84, 16, v84
  v_mul_f32 v86, v84, v241
  v_mfma_f32_32x32x16_bf16 v[164:179], v[224:227], v[184:187], v[164:179]
  v_mul_f32 v87, v85, v241
  v_fma_f32 v84, -v86, v239, v84
  v_fma_f32 v85, -v87, v239, v85
  v_fmac_f32 v86, v84, v241
  v_fmac_f32 v87, v85, v241
  v_cvt_pk_bf16_f32 v70, v86, v87
  v_lshlrev_b32 v84, 16, v71
  v_and_b32 v85, 0xffff0000, v71
  v_sub_f32 v84, v84, v237
  v_sub_f32 v85, v85, v237
  v_cvt_pk_bf16_f32 v84, v84, v85
  v_and_b32 v85, 0xffff0000, v84
  v_lshlrev_b32 v84, 16, v84
  v_mul_f32 v86, v84, v241
  v_mul_f32 v87, v85, v241
  v_fma_f32 v84, -v86, v239, v84
  v_fma_f32 v85, -v87, v239, v85
  v_fmac_f32 v86, v84, v241
  v_fmac_f32 v87, v85, v241
  v_cvt_pk_bf16_f32 v71, v86, v87
  ds_write_b128 v244, v[36:39] offset:0
  ds_write_b128 v245, v[68:71] offset:0
  ds_read_b128 v[184:187], v249 offset:16384
  ds_read_b64_tr_b16 v[208:209], v250 offset:47104
  ds_read_b64_tr_b16 v[210:211], v250 offset:47616
  ds_read_b64_tr_b16 v[212:213], v251 offset:47104
  ds_read_b64_tr_b16 v[214:215], v251 offset:47616
  ds_read_b64_tr_b16 v[216:217], v252 offset:47104
  ds_read_b64_tr_b16 v[218:219], v252 offset:47616
  ds_read_b64_tr_b16 v[220:221], v253 offset:47104
  ds_read_b64_tr_b16 v[222:223], v253 offset:47616
  ds_read_b64_tr_b16 v[224:225], v254 offset:47104
  ds_read_b64_tr_b16 v[226:227], v254 offset:47616
  s_waitcnt lgkmcnt(11)
  v_mfma_f32_32x32x16_bf16 v[100:115], v[188:191], v[180:183], v[100:115]
  v_mfma_f32_32x32x16_bf16 v[116:131], v[192:195], v[180:183], v[116:131]
  v_mfma_f32_32x32x16_bf16 v[132:147], v[196:199], v[180:183], v[132:147]
  v_mfma_f32_32x32x16_bf16 v[148:163], v[200:203], v[180:183], v[148:163]
  v_mfma_f32_32x32x16_bf16 v[164:179], v[204:207], v[180:183], v[164:179]
  s_waitcnt vmcnt(0) lgkmcnt(0)
  s_barrier
  s_add_u32 m0, s50, 40960
  s_nop 0
  global_load_lds_dwordx4 v[10:11], off
  v_add_co_u32 v10, vcc, s44, v10
  v_addc_co_u32 v11, vcc, 0, v11, vcc
  s_add_u32 m0, s50, 41984
  s_nop 0
  global_load_lds_dwordx4 v[12:13], off
  v_add_co_u32 v12, vcc, s45, v12
  v_addc_co_u32 v13, vcc, 0, v13, vcc
  s_add_u32 m0, s50, 43008
  s_nop 0
  global_load_lds_dwordx4 v[14:15], off
  v_add_co_u32 v14, vcc, s46, v14
  v_addc_co_u32 v15, vcc, 0, v15, vcc
  s_add_u32 m0, s50, 44032
  s_nop 0
  global_load_lds_dwordx4 v[16:17], off
  v_add_co_u32 v16, vcc, s47, v16
  v_addc_co_u32 v17, vcc, 0, v17, vcc
  s_add_u32 m0, s50, 45056
  s_nop 0
  global_load_lds_dwordx4 v[18:19], off
  v_add_co_u32 v18, vcc, s48, v18
  v_addc_co_u32 v19, vcc, 0, v19, vcc
  ds_read_b128 v[180:183], v246 offset:0
  ds_read_b64_tr_b16 v[188:189], v250 offset:0
  ds_read_b64_tr_b16 v[190:191], v250 offset:512
  ds_read_b64_tr_b16 v[192:193], v251 offset:0
  ds_read_b64_tr_b16 v[194:195], v251 offset:512
  ds_read_b64_tr_b16 v[196:197], v252 offset:0
  ds_read_b64_tr_b16 v[198:199], v252 offset:512
  ds_read_b64_tr_b16 v[200:201], v253 offset:0
  ds_read_b64_tr_b16 v[202:203], v253 offset:512
  ds_read_b64_tr_b16 v[204:205], v254 offset:0
  ds_read_b64_tr_b16 v[206:207], v254 offset:512
  v_mfma_f32_32x32x16_bf16 v[100:115], v[208:211], v[184:187], v[100:115]
  v_mfma_f32_32x32x16_bf16 v[116:131], v[212:215], v[184:187], v[116:131]
  v_mfma_f32_32x32x16_bf16 v[132:147], v[216:219], v[184:187], v[132:147]
  v_mfma_f32_32x32x16_bf16 v[148:163], v[220:223], v[184:187], v[148:163]
  v_mfma_f32_32x32x16_bf16 v[164:179], v[224:227], v[184:187], v[164:179]
  ds_read_b128 v[184:187], v247 offset:0
  ds_read_b64_tr_b16 v[208:209], v250 offset:2048
  ds_read_b64_tr_b16 v[210:211], v250 offset:2560
  ds_read_b64_tr_b16 v[212:213], v251 offset:2048
  ds_read_b64_tr_b16 v[214:215], v251 offset:2560
  ds_read_b64_tr_b16 v[216:217], v252 offset:2048
  ds_read_b64_tr_b16 v[218:219], v252 offset:2560
  ds_read_b64_tr_b16 v[220:221], v253 offset:2048
  ds_read_b64_tr_b16 v[222:223], v253 offset:2560
  ds_read_b64_tr_b16 v[224:225], v254 offset:2048
  ds_read_b64_tr_b16 v[226:227], v254 offset:2560
  s_waitcnt lgkmcnt(11)
  v_mfma_f32_32x32x16_bf16 v[100:115], v[188:191], v[180:183], v[100:115]
  v_mfma_f32_32x32x16_bf16 v[116:131], v[192:195], v[180:183], v[116:131]
  v_mfma_f32_32x32x16_bf16 v[132:147], v[196:199], v[180:183], v[132:147]
  v_mfma_f32_32x32x16_bf16 v[148:163], v[200:203], v[180:183], v[148:163]
  v_mfma_f32_32x32x16_bf16 v[164:179], v[204:207], v[180:183], v[164:179]
  ds_read_b128 v[180:183], v248 offset:0
  ds_read_b64_tr_b16 v[188:189], v250 offset:4096
  ds_read_b64_tr_b16 v[190:191], v250 offset:4608
  ds_read_b64_tr_b16 v[192:193], v251 offset:4096
  ds_read_b64_tr_b16 v[194:195], v251 offset:4608
  ds_read_b64_tr_b16 v[196:197], v252 offset:4096
  ds_read_b64_tr_b16 v[198:199], v252 offset:4608
  ds_read_b64_tr_b16 v[200:201], v253 offset:4096
  ds_read_b64_tr_b16 v[202:203], v253 offset:4608
  ds_read_b64_tr_b16 v[204:205], v254 offset:4096
  ds_read_b64_tr_b16 v[206:207], v254 offset:4608
  s_waitcnt lgkmcnt(11)
  v_mfma_f32_32x32x16_bf16 v[100:115], v[208:211], v[184:187], v[100:115]
  v_lshlrev_b32 v84, 16, v40
  v_and_b32 v85, 0xffff0000, v40
  v_sub_f32 v84, v84, v236
  v_sub_f32 v85, v85, v236
  v_cvt_pk_bf16_f32 v84, v84, v85
  v_and_b32 v85, 0xffff0000, v84
  v_lshlrev_b32 v84, 16, v84
  v_mul_f32 v86, v84, v240
  v_mul_f32 v87, v85, v240
  v_fma_f32 v84, -v86, v238, v84
  v_fma_f32 v85, -v87, v238, v85
  v_fmac_f32 v86, v84, v240
  v_fmac_f32 v87, v85, v240
  v_cvt_pk_bf16_f32 v40, v86, v87
  v_lshlrev_b32 v84, 16, v41
  v_and_b32 v85, 0xffff0000, v41
  v_sub_f32 v84, v84, v236
  v_sub_f32 v85, v85, v236
  v_cvt_pk_bf16_f32 v84, v84, v85
  v_and_b32 v85, 0xffff0000, v84
  v_lshlrev_b32 v84, 16, v84
  v_mul_f32 v86, v84, v240
  v_mul_f32 v87, v85, v240
  v_mfma_f32_32x32x16_bf16 v[116:131], v[212:215], v[184:187], v[116:131]
  v_fma_f32 v84, -v86, v238, v84
  v_fma_f32 v85, -v87, v238, v85
  v_fmac_f32 v86, v84, v240
  v_fmac_f32 v87, v85, v240
  v_cvt_pk_bf16_f32 v41, v86, v87
  v_lshlrev_b32 v84, 16, v42
  v_and_b32 v85, 0xffff0000, v42
  v_sub_f32 v84, v84, v236
  v_sub_f32 v85, v85, v236
  v_cvt_pk_bf16_f32 v84, v84, v85
  v_and_b32 v85, 0xffff0000, v84
  v_lshlrev_b32 v84, 16, v84
  v_mul_f32 v86, v84, v240
  v_mul_f32 v87, v85, v240
  v_fma_f32 v84, -v86, v238, v84
  v_fma_f32 v85, -v87, v238, v85
  v_fmac_f32 v86, v84, v240
  v_fmac_f32 v87, v85, v240
  v_cvt_pk_bf16_f32 v42, v86, v87
  v_lshlrev_b32 v84, 16, v43
  v_and_b32 v85, 0xffff0000, v43
  v_sub_f32 v84, v84, v236
  v_sub_f32 v85, v85, v236
  v_mfma_f32_32x32x16_bf16 v[132:147], v[216:219], v[184:187], v[132:147]
  v_cvt_pk_bf16_f32 v84, v84, v85
  v_and_b32 v85, 0xffff0000, v84
  v_lshlrev_b32 v84, 16, v84
  v_mul_f32 v86, v84, v240
  v_mul_f32 v87, v85, v240
  v_fma_f32 v84, -v86, v238, v84
  v_fma_f32 v85, -v87, v238, v85
  v_fmac_f32 v86, v84, v240
  v_fmac_f32 v87, v85, v240
  v_cvt_pk_bf16_f32 v43, v86, v87
  v_lshlrev_b32 v84, 16, v72
  v_and_b32 v85, 0xffff0000, v72
  v_sub_f32 v84, v84, v237
  v_sub_f32 v85, v85, v237
  v_cvt_pk_bf16_f32 v84, v84, v85
  v_and_b32 v85, 0xffff0000, v84
  v_lshlrev_b32 v84, 16, v84
  v_mul_f32 v86, v84, v241
  v_mul_f32 v87, v85, v241
  v_fma_f32 v84, -v86, v239, v84
  v_fma_f32 v85, -v87, v239, v85
  v_fmac_f32 v86, v84, v241
  v_fmac_f32 v87, v85, v241
  v_mfma_f32_32x32x16_bf16 v[148:163], v[220:223], v[184:187], v[148:163]
  v_cvt_pk_bf16_f32 v72, v86, v87
  v_lshlrev_b32 v84, 16, v73
  v_and_b32 v85, 0xffff0000, v73
  v_sub_f32 v84, v84, v237
  v_sub_f32 v85, v85, v237
  v_cvt_pk_bf16_f32 v84, v84, v85
  v_and_b32 v85, 0xffff0000, v84
  v_lshlrev_b32 v84, 16, v84
  v_mul_f32 v86, v84, v241
  v_mul_f32 v87, v85, v241
  v_fma_f32 v84, -v86, v239, v84
  v_fma_f32 v85, -v87, v239, v85
  v_fmac_f32 v86, v84, v241
  v_fmac_f32 v87, v85, v241
  v_cvt_pk_bf16_f32 v73, v86, v87
  v_lshlrev_b32 v84, 16, v74
  v_and_b32 v85, 0xffff0000, v74
  v_sub_f32 v84, v84, v237
  v_sub_f32 v85, v85, v237
  v_cvt_pk_bf16_f32 v84, v84, v85
  v_and_b32 v85, 0xffff0000, v84
  v_lshlrev_b32 v84, 16, v84
  v_mul_f32 v86, v84, v241
  v_mfma_f32_32x32x16_bf16 v[164:179], v[224:227], v[184:187], v[164:179]
  v_mul_f32 v87, v85, v241
  v_fma_f32 v84, -v86, v239, v84
  v_fma_f32 v85, -v87, v239, v85
  v_fmac_f32 v86, v84, v241
  v_fmac_f32 v87, v85, v241
  v_cvt_pk_bf16_f32 v74, v86, v87
  v_lshlrev_b32 v84, 16, v75
  v_and_b32 v85, 0xffff0000, v75
  v_sub_f32 v84, v84, v237
  v_sub_f32 v85, v85, v237
  v_cvt_pk_bf16_f32 v84, v84, v85
  v_and_b32 v85, 0xffff0000, v84
  v_lshlrev_b32 v84, 16, v84
  v_mul_f32 v86, v84, v241
  v_mul_f32 v87, v85, v241
  v_fma_f32 v84, -v86, v239, v84
  v_fma_f32 v85, -v87, v239, v85
  v_fmac_f32 v86, v84, v241
  v_fmac_f32 v87, v85, v241
  v_cvt_pk_bf16_f32 v75, v86, v87
  ds_write_b128 v244, v[40:43] offset:16384
  ds_write_b128 v245, v[72:75] offset:16384
  ds_read_b128 v[184:187], v249 offset:0
  ds_read_b64_tr_b16 v[208:209], v250 offset:6144
  ds_read_b64_tr_b16 v[210:211], v250 offset:6656
  ds_read_b64_tr_b16 v[212:213], v251 offset:6144
  ds_read_b64_tr_b16 v[214:215], v251 offset:6656
  ds_read_b64_tr_b16 v[216:217], v252 offset:6144
  ds_read_b64_tr_b16 v[218:219], v252 offset:6656
  ds_read_b64_tr_b16 v[220:221], v253 offset:6144
  ds_read_b64_tr_b16 v[222:223], v253 offset:6656
  ds_read_b64_tr_b16 v[224:225], v254 offset:6144
  ds_read_b64_tr_b16 v[226:227], v254 offset:6656
  s_waitcnt lgkmcnt(11)
  v_mfma_f32_32x32x16_bf16 v[100:115], v[188:191], v[180:183], v[100:115]
  v_mfma_f32_32x32x16_bf16 v[116:131], v[192:195], v[180:183], v[116:131]
  v_mfma_f32_32x32x16_bf16 v[132:147], v[196:199], v[180:183], v[132:147]
  v_mfma_f32_32x32x16_bf16 v[148:163], v[200:203], v[180:183], v[148:163]
  v_mfma_f32_32x32x16_bf16 v[164:179], v[204:207], v[180:183], v[164:179]
  s_waitcnt vmcnt(0) lgkmcnt(0)
  s_barrier
  s_add_u32 m0, s50, 0
  s_nop 0
  global_load_lds_dwordx4 v[10:11], off
  v_add_co_u32 v10, vcc, s44, v10
  v_addc_co_u32 v11, vcc, 0, v11, vcc
  s_add_u32 m0, s50, 1024
  s_nop 0
  global_load_lds_dwordx4 v[12:13], off
  v_add_co_u32 v12, vcc, s45, v12
  v_addc_co_u32 v13, vcc, 0, v13, vcc
  s_add_u32 m0, s50, 2048
  s_nop 0
  global_load_lds_dwordx4 v[14:15], off
  v_add_co_u32 v14, vcc, s46, v14
  v_addc_co_u32 v15, vcc, 0, v15, vcc
  s_add_u32 m0, s50, 3072
  s_nop 0
  global_load_lds_dwordx4 v[16:17], off
  v_add_co_u32 v16, vcc, s47, v16
  v_addc_co_u32 v17, vcc, 0, v17, vcc
  s_add_u32 m0, s50, 4096
  s_nop 0
  global_load_lds_dwordx4 v[18:19], off
  v_add_co_u32 v18, vcc, s48, v18
  v_addc_co_u32 v19, vcc, 0, v19, vcc
  ds_read_b128 v[180:183], v246 offset:16384
  ds_read_b64_tr_b16 v[188:189], v250 offset:40960
  ds_read_b64_tr_b16 v[190:191], v250 offset:41472
  ds_read_b64_tr_b16 v[192:193], v251 offset:40960
  ds_read_b64_tr_b16 v[194:195], v251 offset:41472
  ds_read_b64_tr_b16 v[196:197], v252 offset:40960
  ds_read_b64_tr_b16 v[198:199], v252 offset:41472
  ds_read_b64_tr_b16 v[200:201], v253 offset:40960
  ds_read_b64_tr_b16 v[202:203], v253 offset:41472
  ds_read_b64_tr_b16 v[204:205], v254 offset:40960
  ds_read_b64_tr_b16 v[206:207], v254 offset:41472
  v_mfma_f32_32x32x16_bf16 v[100:115], v[208:211], v[184:187], v[100:115]
  v_mfma_f32_32x32x16_bf16 v[116:131], v[212:215], v[184:187], v[116:131]
  v_mfma_f32_32x32x16_bf16 v[132:147], v[216:219], v[184:187], v[132:147]
  v_mfma_f32_32x32x16_bf16 v[148:163], v[220:223], v[184:187], v[148:163]
  v_mfma_f32_32x32x16_bf16 v[164:179], v[224:227], v[184:187], v[164:179]
  ds_read_b128 v[184:187], v247 offset:16384
  ds_read_b64_tr_b16 v[208:209], v250 offset:43008
  ds_read_b64_tr_b16 v[210:211], v250 offset:43520
  ds_read_b64_tr_b16 v[212:213], v251 offset:43008
  ds_read_b64_tr_b16 v[214:215], v251 offset:43520
  ds_read_b64_tr_b16 v[216:217], v252 offset:43008
  ds_read_b64_tr_b16 v[218:219], v252 offset:43520
  ds_read_b64_tr_b16 v[220:221], v253 offset:43008
  ds_read_b64_tr_b16 v[222:223], v253 offset:43520
  ds_read_b64_tr_b16 v[224:225], v254 offset:43008
  ds_read_b64_tr_b16 v[226:227], v254 offset:43520
  s_waitcnt lgkmcnt(11)
  v_mfma_f32_32x32x16_bf16 v[100:115], v[188:191], v[180:183], v[100:115]
  v_mfma_f32_32x32x16_bf16 v[116:131], v[192:195], v[180:183], v[116:131]
  v_mfma_f32_32x32x16_bf16 v[132:147], v[196:199], v[180:183], v[132:147]
  v_mfma_f32_32x32x16_bf16 v[148:163], v[200:203], v[180:183], v[148:163]
  v_mfma_f32_32x32x16_bf16 v[164:179], v[204:207], v[180:183], v[164:179]
  ds_read_b128 v[180:183], v248 offset:16384
  ds_read_b64_tr_b16 v[188:189], v250 offset:45056
  ds_read_b64_tr_b16 v[190:191], v250 offset:45568
  ds_read_b64_tr_b16 v[192:193], v251 offset:45056
  ds_read_b64_tr_b16 v[194:195], v251 offset:45568
  ds_read_b64_tr_b16 v[196:197], v252 offset:45056
  ds_read_b64_tr_b16 v[198:199], v252 offset:45568
  ds_read_b64_tr_b16 v[200:201], v253 offset:45056
  ds_read_b64_tr_b16 v[202:203], v253 offset:45568
  ds_read_b64_tr_b16 v[204:205], v254 offset:45056
  ds_read_b64_tr_b16 v[206:207], v254 offset:45568
  s_waitcnt lgkmcnt(11)
  v_mfma_f32_32x32x16_bf16 v[100:115], v[208:211], v[184:187], v[100:115]
  v_lshlrev_b32 v84, 16, v44
  v_and_b32 v85, 0xffff0000, v44
  v_sub_f32 v84, v84, v236
  v_sub_f32 v85, v85, v236
  v_cvt_pk_bf16_f32 v84, v84, v85
  v_and_b32 v85, 0xffff0000, v84
  v_lshlrev_b32 v84, 16, v84
  v_mul_f32 v86, v84, v240
  v_mul_f32 v87, v85, v240
  v_fma_f32 v84, -v86, v238, v84
  v_fma_f32 v85, -v87, v238, v85
  v_fmac_f32 v86, v84, v240
  v_fmac_f32 v87, v85, v240
  v_cvt_pk_bf16_f32 v44, v86, v87
  v_lshlrev_b32 v84, 16, v45
  v_and_b32 v85, 0xffff0000, v45
  v_sub_f32 v84, v84, v236
  v_sub_f32 v85, v85, v236
  v_cvt_pk_bf16_f32 v84, v84, v85
  v_and_b32 v85, 0xffff0000, v84
  v_lshlrev_b32 v84, 16, v84
  v_mul_f32 v86, v84, v240
  v_mul_f32 v87, v85, v240
  v_mfma_f32_32x32x16_bf16 v[116:131], v[212:215], v[184:187], v[116:131]
  v_fma_f32 v84, -v86, v238, v84
  v_fma_f32 v85, -v87, v238, v85
  v_fmac_f32 v86, v84, v240
  v_fmac_f32 v87, v85, v240
  v_cvt_pk_bf16_f32 v45, v86, v87
  v_lshlrev_b32 v84, 16, v46
  v_and_b32 v85, 0xffff0000, v46
  v_sub_f32 v84, v84, v236
  v_sub_f32 v85, v85, v236
  v_cvt_pk_bf16_f32 v84, v84, v85
  v_and_b32 v85, 0xffff0000, v84
  v_lshlrev_b32 v84, 16, v84
  v_mul_f32 v86, v84, v240
  v_mul_f32 v87, v85, v240
  v_fma_f32 v84, -v86, v238, v84
  v_fma_f32 v85, -v87, v238, v85
  v_fmac_f32 v86, v84, v240
  v_fmac_f32 v87, v85, v240
  v_cvt_pk_bf16_f32 v46, v86, v87
  v_lshlrev_b32 v84, 16, v47
  v_and_b32 v85, 0xffff0000, v47
  v_sub_f32 v84, v84, v236
  v_sub_f32 v85, v85, v236
  v_mfma_f32_32x32x16_bf16 v[132:147], v[216:219], v[184:187], v[132:147]
  v_cvt_pk_bf16_f32 v84, v84, v85
  v_and_b32 v85, 0xffff0000, v84
  v_lshlrev_b32 v84, 16, v84
  v_mul_f32 v86, v84, v240
  v_mul_f32 v87, v85, v240
  v_fma_f32 v84, -v86, v238, v84
  v_fma_f32 v85, -v87, v238, v85
  v_fmac_f32 v86, v84, v240
  v_fmac_f32 v87, v85, v240
  v_cvt_pk_bf16_f32 v47, v86, v87
  v_lshlrev_b32 v84, 16, v76
  v_and_b32 v85, 0xffff0000, v76
  v_sub_f32 v84, v84, v237
  v_sub_f32 v85, v85, v237
  v_cvt_pk_bf16_f32 v84, v84, v85
  v_and_b32 v85, 0xffff0000, v84
  v_lshlrev_b32 v84, 16, v84
  v_mul_f32 v86, v84, v241
  v_mul_f32 v87, v85, v241
  v_fma_f32 v84, -v86, v239, v84
  v_fma_f32 v85, -v87, v239, v85
  v_fmac_f32 v86, v84, v241
  v_fmac_f32 v87, v85, v241
  v_mfma_f32_32x32x16_bf16 v[148:163], v[220:223], v[184:187], v[148:163]
  v_cvt_pk_bf16_f32 v76, v86, v87
  v_lshlrev_b32 v84, 16, v77
  v_and_b32 v85, 0xffff0000, v77
  v_sub_f32 v84, v84, v237
  v_sub_f32 v85, v85, v237
  v_cvt_pk_bf16_f32 v84, v84, v85
  v_and_b32 v85, 0xffff0000, v84
  v_lshlrev_b32 v84, 16, v84
  v_mul_f32 v86, v84, v241
  v_mul_f32 v87, v85, v241
  v_fma_f32 v84, -v86, v239, v84
  v_fma_f32 v85, -v87, v239, v85
  v_fmac_f32 v86, v84, v241
  v_fmac_f32 v87, v85, v241
  v_cvt_pk_bf16_f32 v77, v86, v87
  v_lshlrev_b32 v84, 16, v78
  v_and_b32 v85, 0xffff0000, v78
  v_sub_f32 v84, v84, v237
  v_sub_f32 v85, v85, v237
  v_cvt_pk_bf16_f32 v84, v84, v85
  v_and_b32 v85, 0xffff0000, v84
  v_lshlrev_b32 v84, 16, v84
  v_mul_f32 v86, v84, v241
  v_mfma_f32_32x32x16_bf16 v[164:179], v[224:227], v[184:187], v[164:179]
  v_mul_f32 v87, v85, v241
  v_fma_f32 v84, -v86, v239, v84
  v_fma_f32 v85, -v87, v239, v85
  v_fmac_f32 v86, v84, v241
  v_fmac_f32 v87, v85, v241
  v_cvt_pk_bf16_f32 v78, v86, v87
  v_lshlrev_b32 v84, 16, v79
  v_and_b32 v85, 0xffff0000, v79
  v_sub_f32 v84, v84, v237
  v_sub_f32 v85, v85, v237
  v_cvt_pk_bf16_f32 v84, v84, v85
  v_and_b32 v85, 0xffff0000, v84
  v_lshlrev_b32 v84, 16, v84
  v_mul_f32 v86, v84, v241
  v_mul_f32 v87, v85, v241
  v_fma_f32 v84, -v86, v239, v84
  v_fma_f32 v85, -v87, v239, v85
  v_fmac_f32 v86, v84, v241
  v_fmac_f32 v87, v85, v241
  v_cvt_pk_bf16_f32 v79, v86, v87
  ds_write_b128 v244, v[44:47] offset:0
  ds_write_b128 v245, v[76:79] offset:0
  ds_read_b128 v[184:187], v249 offset:16384
  ds_read_b64_tr_b16 v[208:209], v250 offset:47104
  ds_read_b64_tr_b16 v[210:211], v250 offset:47616
  ds_read_b64_tr_b16 v[212:213], v251 offset:47104
  ds_read_b64_tr_b16 v[214:215], v251 offset:47616
  ds_read_b64_tr_b16 v[216:217], v252 offset:47104
  ds_read_b64_tr_b16 v[218:219], v252 offset:47616
  ds_read_b64_tr_b16 v[220:221], v253 offset:47104
  ds_read_b64_tr_b16 v[222:223], v253 offset:47616
  ds_read_b64_tr_b16 v[224:225], v254 offset:47104
  ds_read_b64_tr_b16 v[226:227], v254 offset:47616
  s_waitcnt lgkmcnt(11)
  v_mfma_f32_32x32x16_bf16 v[100:115], v[188:191], v[180:183], v[100:115]
  v_mfma_f32_32x32x16_bf16 v[116:131], v[192:195], v[180:183], v[116:131]
  v_mfma_f32_32x32x16_bf16 v[132:147], v[196:199], v[180:183], v[132:147]
  v_mfma_f32_32x32x16_bf16 v[148:163], v[200:203], v[180:183], v[148:163]
  v_mfma_f32_32x32x16_bf16 v[164:179], v[204:207], v[180:183], v[164:179]
  s_waitcnt vmcnt(0) lgkmcnt(0)
  s_barrier
  s_add_u32 m0, s50, 40960
  s_nop 0
  global_load_lds_dwordx4 v[10:11], off
  v_add_co_u32 v10, vcc, s44, v10
  v_addc_co_u32 v11, vcc, 0, v11, vcc
  s_add_u32 m0, s50, 41984
  s_nop 0
  global_load_lds_dwordx4 v[12:13], off
  v_add_co_u32 v12, vcc, s45, v12
  v_addc_co_u32 v13, vcc, 0, v13, vcc
  s_add_u32 m0, s50, 43008
  s_nop 0
  global_load_lds_dwordx4 v[14:15], off
  v_add_co_u32 v14, vcc, s46, v14
  v_addc_co_u32 v15, vcc, 0, v15, vcc
  s_add_u32 m0, s50, 44032
  s_nop 0
  global_load_lds_dwordx4 v[16:17], off
  v_add_co_u32 v16, vcc, s47, v16
  v_addc_co_u32 v17, vcc, 0, v17, vcc
  s_add_u32 m0, s50, 45056
  s_nop 0
  global_load_lds_dwordx4 v[18:19], off
  v_add_co_u32 v18, vcc, s48, v18
  v_addc_co_u32 v19, vcc, 0, v19, vcc
  ds_read_b128 v[180:183], v246 offset:0
  ds_read_b64_tr_b16 v[188:189], v250 offset:0
  ds_read_b64_tr_b16 v[190:191], v250 offset:512
  ds_read_b64_tr_b16 v[192:193], v251 offset:0
  ds_read_b64_tr_b16 v[194:195], v251 offset:512
  ds_read_b64_tr_b16 v[196:197], v252 offset:0
  ds_read_b64_tr_b16 v[198:199], v252 offset:512
  ds_read_b64_tr_b16 v[200:201], v253 offset:0
  ds_read_b64_tr_b16 v[202:203], v253 offset:512
  ds_read_b64_tr_b16 v[204:205], v254 offset:0
  ds_read_b64_tr_b16 v[206:207], v254 offset:512
  v_mfma_f32_32x32x16_bf16 v[100:115], v[208:211], v[184:187], v[100:115]
  v_mfma_f32_32x32x16_bf16 v[116:131], v[212:215], v[184:187], v[116:131]
  v_mfma_f32_32x32x16_bf16 v[132:147], v[216:219], v[184:187], v[132:147]
  v_mfma_f32_32x32x16_bf16 v[148:163], v[220:223], v[184:187], v[148:163]
  v_mfma_f32_32x32x16_bf16 v[164:179], v[224:227], v[184:187], v[164:179]
  ds_read_b128 v[184:187], v247 offset:0
  ds_read_b64_tr_b16 v[208:209], v250 offset:2048
  ds_read_b64_tr_b16 v[210:211], v250 offset:2560
  ds_read_b64_tr_b16 v[212:213], v251 offset:2048
  ds_read_b64_tr_b16 v[214:215], v251 offset:2560
  ds_read_b64_tr_b16 v[216:217], v252 offset:2048
  ds_read_b64_tr_b16 v[218:219], v252 offset:2560
  ds_read_b64_tr_b16 v[220:221], v253 offset:2048
  ds_read_b64_tr_b16 v[222:223], v253 offset:2560
  ds_read_b64_tr_b16 v[224:225], v254 offset:2048
  ds_read_b64_tr_b16 v[226:227], v254 offset:2560
  s_waitcnt lgkmcnt(11)
  v_mfma_f32_32x32x16_bf16 v[100:115], v[188:191], v[180:183], v[100:115]
  v_mfma_f32_32x32x16_bf16 v[116:131], v[192:195], v[180:183], v[116:131]
  v_mfma_f32_32x32x16_bf16 v[132:147], v[196:199], v[180:183], v[132:147]
  v_mfma_f32_32x32x16_bf16 v[148:163], v[200:203], v[180:183], v[148:163]
  v_mfma_f32_32x32x16_bf16 v[164:179], v[204:207], v[180:183], v[164:179]
  ds_read_b128 v[180:183], v248 offset:0
  ds_read_b64_tr_b16 v[188:189], v250 offset:4096
  ds_read_b64_tr_b16 v[190:191], v250 offset:4608
  ds_read_b64_tr_b16 v[192:193], v251 offset:4096
  ds_read_b64_tr_b16 v[194:195], v251 offset:4608
  ds_read_b64_tr_b16 v[196:197], v252 offset:4096
  ds_read_b64_tr_b16 v[198:199], v252 offset:4608
  ds_read_b64_tr_b16 v[200:201], v253 offset:4096
  ds_read_b64_tr_b16 v[202:203], v253 offset:4608
  ds_read_b64_tr_b16 v[204:205], v254 offset:4096
  ds_read_b64_tr_b16 v[206:207], v254 offset:4608
  s_waitcnt lgkmcnt(11)
  v_mfma_f32_32x32x16_bf16 v[100:115], v[208:211], v[184:187], v[100:115]
  v_lshlrev_b32 v84, 16, v48
  v_and_b32 v85, 0xffff0000, v48
  v_sub_f32 v84, v84, v236
  v_sub_f32 v85, v85, v236
  v_cvt_pk_bf16_f32 v84, v84, v85
  v_and_b32 v85, 0xffff0000, v84
  v_lshlrev_b32 v84, 16, v84
  v_mul_f32 v86, v84, v240
  v_mul_f32 v87, v85, v240
  v_fma_f32 v84, -v86, v238, v84
  v_fma_f32 v85, -v87, v238, v85
  v_fmac_f32 v86, v84, v240
  v_fmac_f32 v87, v85, v240
  v_cvt_pk_bf16_f32 v48, v86, v87
  v_lshlrev_b32 v84, 16, v49
  v_and_b32 v85, 0xffff0000, v49
  v_sub_f32 v84, v84, v236
  v_sub_f32 v85, v85, v236
  v_cvt_pk_bf16_f32 v84, v84, v85
  v_and_b32 v85, 0xffff0000, v84
  v_lshlrev_b32 v84, 16, v84
  v_mul_f32 v86, v84, v240
  v_mul_f32 v87, v85, v240
  v_mfma_f32_32x32x16_bf16 v[116:131], v[212:215], v[184:187], v[116:131]
  v_fma_f32 v84, -v86, v238, v84
  v_fma_f32 v85, -v87, v238, v85
  v_fmac_f32 v86, v84, v240
  v_fmac_f32 v87, v85, v240
  v_cvt_pk_bf16_f32 v49, v86, v87
  v_lshlrev_b32 v84, 16, v50
  v_and_b32 v85, 0xffff0000, v50
  v_sub_f32 v84, v84, v236
  v_sub_f32 v85, v85, v236
  v_cvt_pk_bf16_f32 v84, v84, v85
  v_and_b32 v85, 0xffff0000, v84
  v_lshlrev_b32 v84, 16, v84
  v_mul_f32 v86, v84, v240
  v_mul_f32 v87, v85, v240
  v_fma_f32 v84, -v86, v238, v84
  v_fma_f32 v85, -v87, v238, v85
  v_fmac_f32 v86, v84, v240
  v_fmac_f32 v87, v85, v240
  v_cvt_pk_bf16_f32 v50, v86, v87
  v_lshlrev_b32 v84, 16, v51
  v_and_b32 v85, 0xffff0000, v51
  v_sub_f32 v84, v84, v236
  v_sub_f32 v85, v85, v236
  v_mfma_f32_32x32x16_bf16 v[132:147], v[216:219], v[184:187], v[132:147]
  v_cvt_pk_bf16_f32 v84, v84, v85
  v_and_b32 v85, 0xffff0000, v84
  v_lshlrev_b32 v84, 16, v84
  v_mul_f32 v86, v84, v240
  v_mul_f32 v87, v85, v240
  v_fma_f32 v84, -v86, v238, v84
  v_fma_f32 v85, -v87, v238, v85
  v_fmac_f32 v86, v84, v240
  v_fmac_f32 v87, v85, v240
  v_cvt_pk_bf16_f32 v51, v86, v87
  v_lshlrev_b32 v84, 16, v80
  v_and_b32 v85, 0xffff0000, v80
  v_sub_f32 v84, v84, v237
  v_sub_f32 v85, v85, v237
  v_cvt_pk_bf16_f32 v84, v84, v85
  v_and_b32 v85, 0xffff0000, v84
  v_lshlrev_b32 v84, 16, v84
  v_mul_f32 v86, v84, v241
  v_mul_f32 v87, v85, v241
  v_fma_f32 v84, -v86, v239, v84
  v_fma_f32 v85, -v87, v239, v85
  v_fmac_f32 v86, v84, v241
  v_fmac_f32 v87, v85, v241
  v_mfma_f32_32x32x16_bf16 v[148:163], v[220:223], v[184:187], v[148:163]
  v_cvt_pk_bf16_f32 v80, v86, v87
  v_lshlrev_b32 v84, 16, v81
  v_and_b32 v85, 0xffff0000, v81
  v_sub_f32 v84, v84, v237
  v_sub_f32 v85, v85, v237
  v_cvt_pk_bf16_f32 v84, v84, v85
  v_and_b32 v85, 0xffff0000, v84
  v_lshlrev_b32 v84, 16, v84
  v_mul_f32 v86, v84, v241
  v_mul_f32 v87, v85, v241
  v_fma_f32 v84, -v86, v239, v84
  v_fma_f32 v85, -v87, v239, v85
  v_fmac_f32 v86, v84, v241
  v_fmac_f32 v87, v85, v241
  v_cvt_pk_bf16_f32 v81, v86, v87
  v_lshlrev_b32 v84, 16, v82
  v_and_b32 v85, 0xffff0000, v82
  v_sub_f32 v84, v84, v237
  v_sub_f32 v85, v85, v237
  v_cvt_pk_bf16_f32 v84, v84, v85
  v_and_b32 v85, 0xffff0000, v84
  v_lshlrev_b32 v84, 16, v84
  v_mul_f32 v86, v84, v241
  v_mfma_f32_32x32x16_bf16 v[164:179], v[224:227], v[184:187], v[164:179]
  v_mul_f32 v87, v85, v241
  v_fma_f32 v84, -v86, v239, v84
  v_fma_f32 v85, -v87, v239, v85
  v_fmac_f32 v86, v84, v241
  v_fmac_f32 v87, v85, v241
  v_cvt_pk_bf16_f32 v82, v86, v87
  v_lshlrev_b32 v84, 16, v83
  v_and_b32 v85, 0xffff0000, v83
  v_sub_f32 v84, v84, v237
  v_sub_f32 v85, v85, v237
  v_cvt_pk_bf16_f32 v84, v84, v85
  v_and_b32 v85, 0xffff0000, v84
  v_lshlrev_b32 v84, 16, v84
  v_mul_f32 v86, v84, v241
  v_mul_f32 v87, v85, v241
  v_fma_f32 v84, -v86, v239, v84
  v_fma_f32 v85, -v87, v239, v85
  v_fmac_f32 v86, v84, v241
  v_fmac_f32 v87, v85, v241
  v_cvt_pk_bf16_f32 v83, v86, v87
  ds_write_b128 v244, v[48:51] offset:16384
  ds_write_b128 v245, v[80:83] offset:16384
  ds_read_b128 v[184:187], v249 offset:0
  ds_read_b64_tr_b16 v[208:209], v250 offset:6144
  ds_read_b64_tr_b16 v[210:211], v250 offset:6656
  ds_read_b64_tr_b16 v[212:213], v251 offset:6144
  ds_read_b64_tr_b16 v[214:215], v251 offset:6656
  ds_read_b64_tr_b16 v[216:217], v252 offset:6144
  ds_read_b64_tr_b16 v[218:219], v252 offset:6656
  ds_read_b64_tr_b16 v[220:221], v253 offset:6144
  ds_read_b64_tr_b16 v[222:223], v253 offset:6656
  ds_read_b64_tr_b16 v[224:225], v254 offset:6144
  ds_read_b64_tr_b16 v[226:227], v254 offset:6656
  s_waitcnt lgkmcnt(11)
  v_mfma_f32_32x32x16_bf16 v[100:115], v[188:191], v[180:183], v[100:115]
  v_mfma_f32_32x32x16_bf16 v[116:131], v[192:195], v[180:183], v[116:131]
  v_mfma_f32_32x32x16_bf16 v[132:147], v[196:199], v[180:183], v[132:147]
  v_mfma_f32_32x32x16_bf16 v[148:163], v[200:203], v[180:183], v[148:163]
  v_mfma_f32_32x32x16_bf16 v[164:179], v[204:207], v[180:183], v[164:179]
  s_waitcnt vmcnt(0) lgkmcnt(0)
  s_barrier
  ds_read_b128 v[180:183], v246 offset:16384
  ds_read_b64_tr_b16 v[188:189], v250 offset:40960
  ds_read_b64_tr_b16 v[190:191], v250 offset:41472
  ds_read_b64_tr_b16 v[192:193], v251 offset:40960
  ds_read_b64_tr_b16 v[194:195], v251 offset:41472
  ds_read_b64_tr_b16 v[196:197], v252 offset:40960
  ds_read_b64_tr_b16 v[198:199], v252 offset:41472
  ds_read_b64_tr_b16 v[200:201], v253 offset:40960
  ds_read_b64_tr_b16 v[202:203], v253 offset:41472
  ds_read_b64_tr_b16 v[204:205], v254 offset:40960
  ds_read_b64_tr_b16 v[206:207], v254 offset:41472
  v_mfma_f32_32x32x16_bf16 v[100:115], v[208:211], v[184:187], v[100:115]
  v_mfma_f32_32x32x16_bf16 v[116:131], v[212:215], v[184:187], v[116:131]
  v_mfma_f32_32x32x16_bf16 v[132:147], v[216:219], v[184:187], v[132:147]
  v_mfma_f32_32x32x16_bf16 v[148:163], v[220:223], v[184:187], v[148:163]
  v_mfma_f32_32x32x16_bf16 v[164:179], v[224:227], v[184:187], v[164:179]
  ds_read_b128 v[184:187], v247 offset:16384
  ds_read_b64_tr_b16 v[208:209], v250 offset:43008
  ds_read_b64_tr_b16 v[210:211], v250 offset:43520
  ds_read_b64_tr_b16 v[212:213], v251 offset:43008
  ds_read_b64_tr_b16 v[214:215], v251 offset:43520
  ds_read_b64_tr_b16 v[216:217], v252 offset:43008
  ds_read_b64_tr_b16 v[218:219], v252 offset:43520
  ds_read_b64_tr_b16 v[220:221], v253 offset:43008
  ds_read_b64_tr_b16 v[222:223], v253 offset:43520
  ds_read_b64_tr_b16 v[224:225], v254 offset:43008
  ds_read_b64_tr_b16 v[226:227], v254 offset:43520
  s_waitcnt lgkmcnt(11)
  v_mfma_f32_32x32x16_bf16 v[100:115], v[188:191], v[180:183], v[100:115]
  v_mfma_f32_32x32x16_bf16 v[116:131], v[192:195], v[180:183], v[116:131]
  v_mfma_f32_32x32x16_bf16 v[132:147], v[196:199], v[180:183], v[132:147]
  v_mfma_f32_32x32x16_bf16 v[148:163], v[200:203], v[180:183], v[148:163]
  v_mfma_f32_32x32x16_bf16 v[164:179], v[204:207], v[180:183], v[164:179]
  ds_read_b128 v[180:183], v248 offset:16384
  ds_read_b64_tr_b16 v[188:189], v250 offset:45056
  ds_read_b64_tr_b16 v[190:191], v250 offset:45568
  ds_read_b64_tr_b16 v[192:193], v251 offset:45056
  ds_read_b64_tr_b16 v[194:195], v251 offset:45568
  ds_read_b64_tr_b16 v[196:197], v252 offset:45056
  ds_read_b64_tr_b16 v[198:199], v252 offset:45568
  ds_read_b64_tr_b16 v[200:201], v253 offset:45056
  ds_read_b64_tr_b16 v[202:203], v253 offset:45568
  ds_read_b64_tr_b16 v[204:205], v254 offset:45056
  ds_read_b64_tr_b16 v[206:207], v254 offset:45568
  s_waitcnt lgkmcnt(11)
  v_mfma_f32_32x32x16_bf16 v[100:115], v[208:211], v[184:187], v[100:115]
  v_mfma_f32_32x32x16_bf16 v[116:131], v[212:215], v[184:187], v[116:131]
  v_mfma_f32_32x32x16_bf16 v[132:147], v[216:219], v[184:187], v[132:147]
  v_mfma_f32_32x32x16_bf16 v[148:163], v[220:223], v[184:187], v[148:163]
  v_mfma_f32_32x32x16_bf16 v[164:179], v[224:227], v[184:187], v[164:179]
  ds_read_b128 v[184:187], v249 offset:16384
  ds_read_b64_tr_b16 v[208:209], v250 offset:47104
  ds_read_b64_tr_b16 v[210:211], v250 offset:47616
  ds_read_b64_tr_b16 v[212:213], v251 offset:47104
  ds_read_b64_tr_b16 v[214:215], v251 offset:47616
  ds_read_b64_tr_b16 v[216:217], v252 offset:47104
  ds_read_b64_tr_b16 v[218:219], v252 offset:47616
  ds_read_b64_tr_b16 v[220:221], v253 offset:47104
  ds_read_b64_tr_b16 v[222:223], v253 offset:47616
  ds_read_b64_tr_b16 v[224:225], v254 offset:47104
  ds_read_b64_tr_b16 v[226:227], v254 offset:47616
  s_waitcnt lgkmcnt(11)
  v_mfma_f32_32x32x16_bf16 v[100:115], v[188:191], v[180:183], v[100:115]
  v_mfma_f32_32x32x16_bf16 v[116:131], v[192:195], v[180:183], v[116:131]
  v_mfma_f32_32x32x16_bf16 v[132:147], v[196:199], v[180:183], v[132:147]
  v_mfma_f32_32x32x16_bf16 v[148:163], v[200:203], v[180:183], v[148:163]
  v_mfma_f32_32x32x16_bf16 v[164:179], v[204:207], v[180:183], v[164:179]
  s_waitcnt vmcnt(0) lgkmcnt(0)
  s_barrier
  v_mfma_f32_32x32x16_bf16 v[100:115], v[208:211], v[184:187], v[100:115]
  v_mfma_f32_32x32x16_bf16 v[116:131], v[212:215], v[184:187], v[116:131]
  v_mfma_f32_32x32x16_bf16 v[132:147], v[216:219], v[184:187], v[132:147]
  v_mfma_f32_32x32x16_bf16 v[148:163], v[220:223], v[184:187], v[148:163]
  v_mfma_f32_32x32x16_bf16 v[164:179], v[224:227], v[184:187], v[164:179]
  s_nop 15
  s_nop 3
  v_and_b32 v3, 31, v1
  v_lshrrev_b32 v4, 5, v1
  s_lshl_b32 s17, s14, 7
  s_lshl_b32 s18, s20, 5
  s_add_u32 s17, s17, s18
  v_add_u32 v3, s17, v3
  v_lshlrev_b32 v5, 5, v3
  v_lshl_add_u32 v5, v4, 3, v5
  v_add_u32 v6, 0x10000, v5
  s_movk_i32 s24, 3584
  v_mul_lo_u32 v7, v3, s24
  v_lshl_add_u32 v7, v4, 3, v7
  s_add_u32 s36, s12, 8388608
  s_addc_u32 s37, s13, 0
  s_mov_b32 s38, 0xc0135761
  s_mov_b32 s39, 0xbdd2d3e8
  s_lshl_b32 s43, s42, 2
  s_mul_i32 s25, s21, 5
  s_add_u32 s25, s25, 0
  s_cmp_lt_u32 s25, 2
  s_cbranch_scc1 k1_pl0
  s_cmp_lt_u32 s15, 14
  s_cbranch_scc1 k1_ffn0
  s_sub_u32 s26, s25, 2
  s_lshr_b32 s27, s26, 2
  s_and_b32 s26, s26, 3
  s_lshl_b32 s27, s27, 3
  s_add_u32 s26, s26, s27
  s_add_u32 s26, s26, s43
  s_add_u32 s26, s26, 4
  s_add_u32 s27, s26, 4
  s_branch k1_q0
k1_pl0:
  s_lshl_b32 s26, s25, 1
  s_add_u32 s26, s26, s43
  s_add_u32 s27, s26, 1
k1_q0:
  s_lshl_b32 s26, s26, 16
  s_lshl_b32 s27, s27, 16
  s_add_u32 s28, s12, s26
  s_addc_u32 s29, s13, 0
  s_add_u32 s30, s12, s27
  s_addc_u32 s31, s13, 0
  v_cvt_pk_bf16_f32 v84, v100, v101
  v_cvt_pk_bf16_f32 v85, v102, v103
  global_store_dwordx2 v5, v[84:85], s[28:29] offset:0
  s_nop 0
  v_cvt_pk_bf16_f32 v84, v104, v105
  v_cvt_pk_bf16_f32 v85, v106, v107
  global_store_dwordx2 v5, v[84:85], s[28:29] offset:16
  s_nop 0
  v_cvt_pk_bf16_f32 v84, v108, v109
  v_cvt_pk_bf16_f32 v85, v110, v111
  global_store_dwordx2 v5, v[84:85], s[30:31] offset:0
  s_nop 0
  v_cvt_pk_bf16_f32 v84, v112, v113
  v_cvt_pk_bf16_f32 v85, v114, v115
  global_store_dwordx2 v5, v[84:85], s[30:31] offset:16
  s_nop 0
  s_branch k1_nx0
k1_ffn0:
  s_sub_u32 s26, s25, 2
  s_lshl_b32 s26, s26, 5
  s_lshl_b32 s27, s15, 8
  s_add_u32 s26, s26, s27
  v_add_u32 v8, s26, v7
  v_cvt_pk_bf16_f32 v100, v100, v100
  v_lshlrev_b32 v100, 16, v100
  v_cvt_pk_bf16_f32 v108, v108, v108
  v_lshlrev_b32 v108, 16, v108
  v_mul_f32 v84, v100, v100
  v_mov_b32 v85, s38
  v_fmac_f32 v85, s39, v84
  v_mul_f32 v85, v85, v100
  v_exp_f32 v85, v85
  s_nop 0
  v_add_f32 v85, 1.0, v85
  v_rcp_f32 v85, v85
  s_nop 0
  v_mul_f32 v85, v85, v100
  v_cvt_pk_bf16_f32 v85, v85, v85
  v_lshlrev_b32 v85, 16, v85
  v_mul_f32 v86, v85, v108
  v_cvt_pk_bf16_f32 v101, v101, v101
  v_lshlrev_b32 v101, 16, v101
  v_cvt_pk_bf16_f32 v109, v109, v109
  v_lshlrev_b32 v109, 16, v109
  v_mul_f32 v84, v101, v101
  v_mov_b32 v85, s38
  v_fmac_f32 v85, s39, v84
  v_mul_f32 v85, v85, v101
  v_exp_f32 v85, v85
  s_nop 0
  v_add_f32 v85, 1.0, v85
  v_rcp_f32 v85, v85
  s_nop 0
  v_mul_f32 v85, v85, v101
  v_cvt_pk_bf16_f32 v85, v85, v85
  v_lshlrev_b32 v85, 16, v85
  v_mul_f32 v87, v85, v109
  v_cvt_pk_bf16_f32 v102, v102, v102
  v_lshlrev_b32 v102, 16, v102
  v_cvt_pk_bf16_f32 v110, v110, v110
  v_lshlrev_b32 v110, 16, v110
  v_mul_f32 v84, v102, v102
  v_mov_b32 v85, s38
  v_fmac_f32 v85, s39, v84
  v_mul_f32 v85, v85, v102
  v_exp_f32 v85, v85
  s_nop 0
  v_add_f32 v85, 1.0, v85
  v_rcp_f32 v85, v85
  s_nop 0
  v_mul_f32 v85, v85, v102
  v_cvt_pk_bf16_f32 v85, v85, v85
  v_lshlrev_b32 v85, 16, v85
  v_mul_f32 v88, v85, v110
  v_cvt_pk_bf16_f32 v103, v103, v103
  v_lshlrev_b32 v103, 16, v103
  v_cvt_pk_bf16_f32 v111, v111, v111
  v_lshlrev_b32 v111, 16, v111
  v_mul_f32 v84, v103, v103
  v_mov_b32 v85, s38
  v_fmac_f32 v85, s39, v84
  v_mul_f32 v85, v85, v103
  v_exp_f32 v85, v85
  s_nop 0
  v_add_f32 v85, 1.0, v85
  v_rcp_f32 v85, v85
  s_nop 0
  v_mul_f32 v85, v85, v103
  v_cvt_pk_bf16_f32 v85, v85, v85
  v_lshlrev_b32 v85, 16, v85
  v_mul_f32 v89, v85, v111
  v_cvt_pk_bf16_f32 v84, v86, v87
  v_cvt_pk_bf16_f32 v85, v88, v89
  global_store_dwordx2 v8, v[84:85], s[36:37] offset:0
  s_nop 0
  v_cvt_pk_bf16_f32 v104, v104, v104
  v_lshlrev_b32 v104, 16, v104
  v_cvt_pk_bf16_f32 v112, v112, v112
  v_lshlrev_b32 v112, 16, v112
  v_mul_f32 v84, v104, v104
  v_mov_b32 v85, s38
  v_fmac_f32 v85, s39, v84
  v_mul_f32 v85, v85, v104
  v_exp_f32 v85, v85
  s_nop 0
  v_add_f32 v85, 1.0, v85
  v_rcp_f32 v85, v85
  s_nop 0
  v_mul_f32 v85, v85, v104
  v_cvt_pk_bf16_f32 v85, v85, v85
  v_lshlrev_b32 v85, 16, v85
  v_mul_f32 v86, v85, v112
  v_cvt_pk_bf16_f32 v105, v105, v105
  v_lshlrev_b32 v105, 16, v105
  v_cvt_pk_bf16_f32 v113, v113, v113
  v_lshlrev_b32 v113, 16, v113
  v_mul_f32 v84, v105, v105
  v_mov_b32 v85, s38
  v_fmac_f32 v85, s39, v84
  v_mul_f32 v85, v85, v105
  v_exp_f32 v85, v85
  s_nop 0
  v_add_f32 v85, 1.0, v85
  v_rcp_f32 v85, v85
  s_nop 0
  v_mul_f32 v85, v85, v105
  v_cvt_pk_bf16_f32 v85, v85, v85
  v_lshlrev_b32 v85, 16, v85
  v_mul_f32 v87, v85, v113
  v_cvt_pk_bf16_f32 v106, v106, v106
  v_lshlrev_b32 v106, 16, v106
  v_cvt_pk_bf16_f32 v114, v114, v114
  v_lshlrev_b32 v114, 16, v114
  v_mul_f32 v84, v106, v106
  v_mov_b32 v85, s38
  v_fmac_f32 v85, s39, v84
  v_mul_f32 v85, v85, v106
  v_exp_f32 v85, v85
  s_nop 0
  v_add_f32 v85, 1.0, v85
  v_rcp_f32 v85, v85
  s_nop 0
  v_mul_f32 v85, v85, v106
  v_cvt_pk_bf16_f32 v85, v85, v85
  v_lshlrev_b32 v85, 16, v85
  v_mul_f32 v88, v85, v114
  v_cvt_pk_bf16_f32 v107, v107, v107
  v_lshlrev_b32 v107, 16, v107
  v_cvt_pk_bf16_f32 v115, v115, v115
  v_lshlrev_b32 v115, 16, v115
  v_mul_f32 v84, v107, v107
  v_mov_b32 v85, s38
  v_fmac_f32 v85, s39, v84
  v_mul_f32 v85, v85, v107
  v_exp_f32 v85, v85
  s_nop 0
  v_add_f32 v85, 1.0, v85
  v_rcp_f32 v85, v85
  s_nop 0
  v_mul_f32 v85, v85, v107
  v_cvt_pk_bf16_f32 v85, v85, v85
  v_lshlrev_b32 v85, 16, v85
  v_mul_f32 v89, v85, v115
  v_cvt_pk_bf16_f32 v84, v86, v87
  v_cvt_pk_bf16_f32 v85, v88, v89
  global_store_dwordx2 v8, v[84:85], s[36:37] offset:16
  s_nop 0
k1_nx0:
  s_mul_i32 s25, s21, 5
  s_add_u32 s25, s25, 1
  s_cmp_lt_u32 s25, 2
  s_cbranch_scc1 k1_pl1
  s_cmp_lt_u32 s15, 14
  s_cbranch_scc1 k1_ffn1
  s_sub_u32 s26, s25, 2
  s_lshr_b32 s27, s26, 2
  s_and_b32 s26, s26, 3
  s_lshl_b32 s27, s27, 3
  s_add_u32 s26, s26, s27
  s_add_u32 s26, s26, s43
  s_add_u32 s26, s26, 4
  s_add_u32 s27, s26, 4
  s_branch k1_q1
k1_pl1:
  s_lshl_b32 s26, s25, 1
  s_add_u32 s26, s26, s43
  s_add_u32 s27, s26, 1
k1_q1:
  s_lshl_b32 s26, s26, 16
  s_lshl_b32 s27, s27, 16
  s_add_u32 s28, s12, s26
  s_addc_u32 s29, s13, 0
  s_add_u32 s30, s12, s27
  s_addc_u32 s31, s13, 0
  v_cvt_pk_bf16_f32 v84, v116, v117
  v_cvt_pk_bf16_f32 v85, v118, v119
  global_store_dwordx2 v5, v[84:85], s[28:29] offset:0
  s_nop 0
  v_cvt_pk_bf16_f32 v84, v120, v121
  v_cvt_pk_bf16_f32 v85, v122, v123
  global_store_dwordx2 v5, v[84:85], s[28:29] offset:16
  s_nop 0
  v_cvt_pk_bf16_f32 v84, v124, v125
  v_cvt_pk_bf16_f32 v85, v126, v127
  global_store_dwordx2 v5, v[84:85], s[30:31] offset:0
  s_nop 0
  v_cvt_pk_bf16_f32 v84, v128, v129
  v_cvt_pk_bf16_f32 v85, v130, v131
  global_store_dwordx2 v5, v[84:85], s[30:31] offset:16
  s_nop 0
  s_branch k1_nx1
k1_ffn1:
  s_sub_u32 s26, s25, 2
  s_lshl_b32 s26, s26, 5
  s_lshl_b32 s27, s15, 8
  s_add_u32 s26, s26, s27
  v_add_u32 v8, s26, v7
  v_cvt_pk_bf16_f32 v116, v116, v116
  v_lshlrev_b32 v116, 16, v116
  v_cvt_pk_bf16_f32 v124, v124, v124
  v_lshlrev_b32 v124, 16, v124
  v_mul_f32 v84, v116, v116
  v_mov_b32 v85, s38
  v_fmac_f32 v85, s39, v84
  v_mul_f32 v85, v85, v116
  v_exp_f32 v85, v85
  s_nop 0
  v_add_f32 v85, 1.0, v85
  v_rcp_f32 v85, v85
  s_nop 0
  v_mul_f32 v85, v85, v116
  v_cvt_pk_bf16_f32 v85, v85, v85
  v_lshlrev_b32 v85, 16, v85
  v_mul_f32 v86, v85, v124
  v_cvt_pk_bf16_f32 v117, v117, v117
  v_lshlrev_b32 v117, 16, v117
  v_cvt_pk_bf16_f32 v125, v125, v125
  v_lshlrev_b32 v125, 16, v125
  v_mul_f32 v84, v117, v117
  v_mov_b32 v85, s38
  v_fmac_f32 v85, s39, v84
  v_mul_f32 v85, v85, v117
  v_exp_f32 v85, v85
  s_nop 0
  v_add_f32 v85, 1.0, v85
  v_rcp_f32 v85, v85
  s_nop 0
  v_mul_f32 v85, v85, v117
  v_cvt_pk_bf16_f32 v85, v85, v85
  v_lshlrev_b32 v85, 16, v85
  v_mul_f32 v87, v85, v125
  v_cvt_pk_bf16_f32 v118, v118, v118
  v_lshlrev_b32 v118, 16, v118
  v_cvt_pk_bf16_f32 v126, v126, v126
  v_lshlrev_b32 v126, 16, v126
  v_mul_f32 v84, v118, v118
  v_mov_b32 v85, s38
  v_fmac_f32 v85, s39, v84
  v_mul_f32 v85, v85, v118
  v_exp_f32 v85, v85
  s_nop 0
  v_add_f32 v85, 1.0, v85
  v_rcp_f32 v85, v85
  s_nop 0
  v_mul_f32 v85, v85, v118
  v_cvt_pk_bf16_f32 v85, v85, v85
  v_lshlrev_b32 v85, 16, v85
  v_mul_f32 v88, v85, v126
  v_cvt_pk_bf16_f32 v119, v119, v119
  v_lshlrev_b32 v119, 16, v119
  v_cvt_pk_bf16_f32 v127, v127, v127
  v_lshlrev_b32 v127, 16, v127
  v_mul_f32 v84, v119, v119
  v_mov_b32 v85, s38
  v_fmac_f32 v85, s39, v84
  v_mul_f32 v85, v85, v119
  v_exp_f32 v85, v85
  s_nop 0
  v_add_f32 v85, 1.0, v85
  v_rcp_f32 v85, v85
  s_nop 0
  v_mul_f32 v85, v85, v119
  v_cvt_pk_bf16_f32 v85, v85, v85
  v_lshlrev_b32 v85, 16, v85
  v_mul_f32 v89, v85, v127
  v_cvt_pk_bf16_f32 v84, v86, v87
  v_cvt_pk_bf16_f32 v85, v88, v89
  global_store_dwordx2 v8, v[84:85], s[36:37] offset:0
  s_nop 0
  v_cvt_pk_bf16_f32 v120, v120, v120
  v_lshlrev_b32 v120, 16, v120
  v_cvt_pk_bf16_f32 v128, v128, v128
  v_lshlrev_b32 v128, 16, v128
  v_mul_f32 v84, v120, v120
  v_mov_b32 v85, s38
  v_fmac_f32 v85, s39, v84
  v_mul_f32 v85, v85, v120
  v_exp_f32 v85, v85
  s_nop 0
  v_add_f32 v85, 1.0, v85
  v_rcp_f32 v85, v85
  s_nop 0
  v_mul_f32 v85, v85, v120
  v_cvt_pk_bf16_f32 v85, v85, v85
  v_lshlrev_b32 v85, 16, v85
  v_mul_f32 v86, v85, v128
  v_cvt_pk_bf16_f32 v121, v121, v121
  v_lshlrev_b32 v121, 16, v121
  v_cvt_pk_bf16_f32 v129, v129, v129
  v_lshlrev_b32 v129, 16, v129
  v_mul_f32 v84, v121, v121
  v_mov_b32 v85, s38
  v_fmac_f32 v85, s39, v84
  v_mul_f32 v85, v85, v121
  v_exp_f32 v85, v85
  s_nop 0
  v_add_f32 v85, 1.0, v85
  v_rcp_f32 v85, v85
  s_nop 0
  v_mul_f32 v85, v85, v121
  v_cvt_pk_bf16_f32 v85, v85, v85
  v_lshlrev_b32 v85, 16, v85
  v_mul_f32 v87, v85, v129
  v_cvt_pk_bf16_f32 v122, v122, v122
  v_lshlrev_b32 v122, 16, v122
  v_cvt_pk_bf16_f32 v130, v130, v130
  v_lshlrev_b32 v130, 16, v130
  v_mul_f32 v84, v122, v122
  v_mov_b32 v85, s38
  v_fmac_f32 v85, s39, v84
  v_mul_f32 v85, v85, v122
  v_exp_f32 v85, v85
  s_nop 0
  v_add_f32 v85, 1.0, v85
  v_rcp_f32 v85, v85
  s_nop 0
  v_mul_f32 v85, v85, v122
  v_cvt_pk_bf16_f32 v85, v85, v85
  v_lshlrev_b32 v85, 16, v85
  v_mul_f32 v88, v85, v130
  v_cvt_pk_bf16_f32 v123, v123, v123
  v_lshlrev_b32 v123, 16, v123
  v_cvt_pk_bf16_f32 v131, v131, v131
  v_lshlrev_b32 v131, 16, v131
  v_mul_f32 v84, v123, v123
  v_mov_b32 v85, s38
  v_fmac_f32 v85, s39, v84
  v_mul_f32 v85, v85, v123
  v_exp_f32 v85, v85
  s_nop 0
  v_add_f32 v85, 1.0, v85
  v_rcp_f32 v85, v85
  s_nop 0
  v_mul_f32 v85, v85, v123
  v_cvt_pk_bf16_f32 v85, v85, v85
  v_lshlrev_b32 v85, 16, v85
  v_mul_f32 v89, v85, v131
  v_cvt_pk_bf16_f32 v84, v86, v87
  v_cvt_pk_bf16_f32 v85, v88, v89
  global_store_dwordx2 v8, v[84:85], s[36:37] offset:16
  s_nop 0
k1_nx1:
  s_mul_i32 s25, s21, 5
  s_add_u32 s25, s25, 2
  s_cmp_lt_u32 s25, 2
  s_cbranch_scc1 k1_pl2
  s_cmp_lt_u32 s15, 14
  s_cbranch_scc1 k1_ffn2
  s_sub_u32 s26, s25, 2
  s_lshr_b32 s27, s26, 2
  s_and_b32 s26, s26, 3
  s_lshl_b32 s27, s27, 3
  s_add_u32 s26, s26, s27
  s_add_u32 s26, s26, s43
  s_add_u32 s26, s26, 4
  s_add_u32 s27, s26, 4
  s_branch k1_q2
k1_pl2:
  s_lshl_b32 s26, s25, 1
  s_add_u32 s26, s26, s43
  s_add_u32 s27, s26, 1
k1_q2:
  s_lshl_b32 s26, s26, 16
  s_lshl_b32 s27, s27, 16
  s_add_u32 s28, s12, s26
  s_addc_u32 s29, s13, 0
  s_add_u32 s30, s12, s27
  s_addc_u32 s31, s13, 0
  v_cvt_pk_bf16_f32 v84, v132, v133
  v_cvt_pk_bf16_f32 v85, v134, v135
  global_store_dwordx2 v5, v[84:85], s[28:29] offset:0
  s_nop 0
  v_cvt_pk_bf16_f32 v84, v136, v137
  v_cvt_pk_bf16_f32 v85, v138, v139
  global_store_dwordx2 v5, v[84:85], s[28:29] offset:16
  s_nop 0
  v_cvt_pk_bf16_f32 v84, v140, v141
  v_cvt_pk_bf16_f32 v85, v142, v143
  global_store_dwordx2 v5, v[84:85], s[30:31] offset:0
  s_nop 0
  v_cvt_pk_bf16_f32 v84, v144, v145
  v_cvt_pk_bf16_f32 v85, v146, v147
  global_store_dwordx2 v5, v[84:85], s[30:31] offset:16
  s_nop 0
  s_branch k1_nx2
k1_ffn2:
  s_sub_u32 s26, s25, 2
  s_lshl_b32 s26, s26, 5
  s_lshl_b32 s27, s15, 8
  s_add_u32 s26, s26, s27
  v_add_u32 v8, s26, v7
  v_cvt_pk_bf16_f32 v132, v132, v132
  v_lshlrev_b32 v132, 16, v132
  v_cvt_pk_bf16_f32 v140, v140, v140
  v_lshlrev_b32 v140, 16, v140
  v_mul_f32 v84, v132, v132
  v_mov_b32 v85, s38
  v_fmac_f32 v85, s39, v84
  v_mul_f32 v85, v85, v132
  v_exp_f32 v85, v85
  s_nop 0
  v_add_f32 v85, 1.0, v85
  v_rcp_f32 v85, v85
  s_nop 0
  v_mul_f32 v85, v85, v132
  v_cvt_pk_bf16_f32 v85, v85, v85
  v_lshlrev_b32 v85, 16, v85
  v_mul_f32 v86, v85, v140
  v_cvt_pk_bf16_f32 v133, v133, v133
  v_lshlrev_b32 v133, 16, v133
  v_cvt_pk_bf16_f32 v141, v141, v141
  v_lshlrev_b32 v141, 16, v141
  v_mul_f32 v84, v133, v133
  v_mov_b32 v85, s38
  v_fmac_f32 v85, s39, v84
  v_mul_f32 v85, v85, v133
  v_exp_f32 v85, v85
  s_nop 0
  v_add_f32 v85, 1.0, v85
  v_rcp_f32 v85, v85
  s_nop 0
  v_mul_f32 v85, v85, v133
  v_cvt_pk_bf16_f32 v85, v85, v85
  v_lshlrev_b32 v85, 16, v85
  v_mul_f32 v87, v85, v141
  v_cvt_pk_bf16_f32 v134, v134, v134
  v_lshlrev_b32 v134, 16, v134
  v_cvt_pk_bf16_f32 v142, v142, v142
  v_lshlrev_b32 v142, 16, v142
  v_mul_f32 v84, v134, v134
  v_mov_b32 v85, s38
  v_fmac_f32 v85, s39, v84
  v_mul_f32 v85, v85, v134
  v_exp_f32 v85, v85
  s_nop 0
  v_add_f32 v85, 1.0, v85
  v_rcp_f32 v85, v85
  s_nop 0
  v_mul_f32 v85, v85, v134
  v_cvt_pk_bf16_f32 v85, v85, v85
  v_lshlrev_b32 v85, 16, v85
  v_mul_f32 v88, v85, v142
  v_cvt_pk_bf16_f32 v135, v135, v135
  v_lshlrev_b32 v135, 16, v135
  v_cvt_pk_bf16_f32 v143, v143, v143
  v_lshlrev_b32 v143, 16, v143
  v_mul_f32 v84, v135, v135
  v_mov_b32 v85, s38
  v_fmac_f32 v85, s39, v84
  v_mul_f32 v85, v85, v135
  v_exp_f32 v85, v85
  s_nop 0
  v_add_f32 v85, 1.0, v85
  v_rcp_f32 v85, v85
  s_nop 0
  v_mul_f32 v85, v85, v135
  v_cvt_pk_bf16_f32 v85, v85, v85
  v_lshlrev_b32 v85, 16, v85
  v_mul_f32 v89, v85, v143
  v_cvt_pk_bf16_f32 v84, v86, v87
  v_cvt_pk_bf16_f32 v85, v88, v89
  global_store_dwordx2 v8, v[84:85], s[36:37] offset:0
  s_nop 0
  v_cvt_pk_bf16_f32 v136, v136, v136
  v_lshlrev_b32 v136, 16, v136
  v_cvt_pk_bf16_f32 v144, v144, v144
  v_lshlrev_b32 v144, 16, v144
  v_mul_f32 v84, v136, v136
  v_mov_b32 v85, s38
  v_fmac_f32 v85, s39, v84
  v_mul_f32 v85, v85, v136
  v_exp_f32 v85, v85
  s_nop 0
  v_add_f32 v85, 1.0, v85
  v_rcp_f32 v85, v85
  s_nop 0
  v_mul_f32 v85, v85, v136
  v_cvt_pk_bf16_f32 v85, v85, v85
  v_lshlrev_b32 v85, 16, v85
  v_mul_f32 v86, v85, v144
  v_cvt_pk_bf16_f32 v137, v137, v137
  v_lshlrev_b32 v137, 16, v137
  v_cvt_pk_bf16_f32 v145, v145, v145
  v_lshlrev_b32 v145, 16, v145
  v_mul_f32 v84, v137, v137
  v_mov_b32 v85, s38
  v_fmac_f32 v85, s39, v84
  v_mul_f32 v85, v85, v137
  v_exp_f32 v85, v85
  s_nop 0
  v_add_f32 v85, 1.0, v85
  v_rcp_f32 v85, v85
  s_nop 0
  v_mul_f32 v85, v85, v137
  v_cvt_pk_bf16_f32 v85, v85, v85
  v_lshlrev_b32 v85, 16, v85
  v_mul_f32 v87, v85, v145
  v_cvt_pk_bf16_f32 v138, v138, v138
  v_lshlrev_b32 v138, 16, v138
  v_cvt_pk_bf16_f32 v146, v146, v146
  v_lshlrev_b32 v146, 16, v146
  v_mul_f32 v84, v138, v138
  v_mov_b32 v85, s38
  v_fmac_f32 v85, s39, v84
  v_mul_f32 v85, v85, v138
  v_exp_f32 v85, v85
  s_nop 0
  v_add_f32 v85, 1.0, v85
  v_rcp_f32 v85, v85
  s_nop 0
  v_mul_f32 v85, v85, v138
  v_cvt_pk_bf16_f32 v85, v85, v85
  v_lshlrev_b32 v85, 16, v85
  v_mul_f32 v88, v85, v146
  v_cvt_pk_bf16_f32 v139, v139, v139
  v_lshlrev_b32 v139, 16, v139
  v_cvt_pk_bf16_f32 v147, v147, v147
  v_lshlrev_b32 v147, 16, v147
  v_mul_f32 v84, v139, v139
  v_mov_b32 v85, s38
  v_fmac_f32 v85, s39, v84
  v_mul_f32 v85, v85, v139
  v_exp_f32 v85, v85
  s_nop 0
  v_add_f32 v85, 1.0, v85
  v_rcp_f32 v85, v85
  s_nop 0
  v_mul_f32 v85, v85, v139
  v_cvt_pk_bf16_f32 v85, v85, v85
  v_lshlrev_b32 v85, 16, v85
  v_mul_f32 v89, v85, v147
  v_cvt_pk_bf16_f32 v84, v86, v87
  v_cvt_pk_bf16_f32 v85, v88, v89
  global_store_dwordx2 v8, v[84:85], s[36:37] offset:16
  s_nop 0
k1_nx2:
  s_mul_i32 s25, s21, 5
  s_add_u32 s25, s25, 3
  s_cmp_lt_u32 s25, 2
  s_cbranch_scc1 k1_pl3
  s_cmp_lt_u32 s15, 14
  s_cbranch_scc1 k1_ffn3
  s_sub_u32 s26, s25, 2
  s_lshr_b32 s27, s26, 2
  s_and_b32 s26, s26, 3
  s_lshl_b32 s27, s27, 3
  s_add_u32 s26, s26, s27
  s_add_u32 s26, s26, s43
  s_add_u32 s26, s26, 4
  s_add_u32 s27, s26, 4
  s_branch k1_q3
k1_pl3:
  s_lshl_b32 s26, s25, 1
  s_add_u32 s26, s26, s43
  s_add_u32 s27, s26, 1
k1_q3:
  s_lshl_b32 s26, s26, 16
  s_lshl_b32 s27, s27, 16
  s_add_u32 s28, s12, s26
  s_addc_u32 s29, s13, 0
  s_add_u32 s30, s12, s27
  s_addc_u32 s31, s13, 0
  v_cvt_pk_bf16_f32 v84, v148, v149
  v_cvt_pk_bf16_f32 v85, v150, v151
  global_store_dwordx2 v5, v[84:85], s[28:29] offset:0
  s_nop 0
  v_cvt_pk_bf16_f32 v84, v152, v153
  v_cvt_pk_bf16_f32 v85, v154, v155
  global_store_dwordx2 v5, v[84:85], s[28:29] offset:16
  s_nop 0
  v_cvt_pk_bf16_f32 v84, v156, v157
  v_cvt_pk_bf16_f32 v85, v158, v159
  global_store_dwordx2 v5, v[84:85], s[30:31] offset:0
  s_nop 0
  v_cvt_pk_bf16_f32 v84, v160, v161
  v_cvt_pk_bf16_f32 v85, v162, v163
  global_store_dwordx2 v5, v[84:85], s[30:31] offset:16
  s_nop 0
  s_branch k1_nx3
k1_ffn3:
  s_sub_u32 s26, s25, 2
  s_lshl_b32 s26, s26, 5
  s_lshl_b32 s27, s15, 8
  s_add_u32 s26, s26, s27
  v_add_u32 v8, s26, v7
  v_cvt_pk_bf16_f32 v148, v148, v148
  v_lshlrev_b32 v148, 16, v148
  v_cvt_pk_bf16_f32 v156, v156, v156
  v_lshlrev_b32 v156, 16, v156
  v_mul_f32 v84, v148, v148
  v_mov_b32 v85, s38
  v_fmac_f32 v85, s39, v84
  v_mul_f32 v85, v85, v148
  v_exp_f32 v85, v85
  s_nop 0
  v_add_f32 v85, 1.0, v85
  v_rcp_f32 v85, v85
  s_nop 0
  v_mul_f32 v85, v85, v148
  v_cvt_pk_bf16_f32 v85, v85, v85
  v_lshlrev_b32 v85, 16, v85
  v_mul_f32 v86, v85, v156
  v_cvt_pk_bf16_f32 v149, v149, v149
  v_lshlrev_b32 v149, 16, v149
  v_cvt_pk_bf16_f32 v157, v157, v157
  v_lshlrev_b32 v157, 16, v157
  v_mul_f32 v84, v149, v149
  v_mov_b32 v85, s38
  v_fmac_f32 v85, s39, v84
  v_mul_f32 v85, v85, v149
  v_exp_f32 v85, v85
  s_nop 0
  v_add_f32 v85, 1.0, v85
  v_rcp_f32 v85, v85
  s_nop 0
  v_mul_f32 v85, v85, v149
  v_cvt_pk_bf16_f32 v85, v85, v85
  v_lshlrev_b32 v85, 16, v85
  v_mul_f32 v87, v85, v157
  v_cvt_pk_bf16_f32 v150, v150, v150
  v_lshlrev_b32 v150, 16, v150
  v_cvt_pk_bf16_f32 v158, v158, v158
  v_lshlrev_b32 v158, 16, v158
  v_mul_f32 v84, v150, v150
  v_mov_b32 v85, s38
  v_fmac_f32 v85, s39, v84
  v_mul_f32 v85, v85, v150
  v_exp_f32 v85, v85
  s_nop 0
  v_add_f32 v85, 1.0, v85
  v_rcp_f32 v85, v85
  s_nop 0
  v_mul_f32 v85, v85, v150
  v_cvt_pk_bf16_f32 v85, v85, v85
  v_lshlrev_b32 v85, 16, v85
  v_mul_f32 v88, v85, v158
  v_cvt_pk_bf16_f32 v151, v151, v151
  v_lshlrev_b32 v151, 16, v151
  v_cvt_pk_bf16_f32 v159, v159, v159
  v_lshlrev_b32 v159, 16, v159
  v_mul_f32 v84, v151, v151
  v_mov_b32 v85, s38
  v_fmac_f32 v85, s39, v84
  v_mul_f32 v85, v85, v151
  v_exp_f32 v85, v85
  s_nop 0
  v_add_f32 v85, 1.0, v85
  v_rcp_f32 v85, v85
  s_nop 0
  v_mul_f32 v85, v85, v151
  v_cvt_pk_bf16_f32 v85, v85, v85
  v_lshlrev_b32 v85, 16, v85
  v_mul_f32 v89, v85, v159
  v_cvt_pk_bf16_f32 v84, v86, v87
  v_cvt_pk_bf16_f32 v85, v88, v89
  global_store_dwordx2 v8, v[84:85], s[36:37] offset:0
  s_nop 0
  v_cvt_pk_bf16_f32 v152, v152, v152
  v_lshlrev_b32 v152, 16, v152
  v_cvt_pk_bf16_f32 v160, v160, v160
  v_lshlrev_b32 v160, 16, v160
  v_mul_f32 v84, v152, v152
  v_mov_b32 v85, s38
  v_fmac_f32 v85, s39, v84
  v_mul_f32 v85, v85, v152
  v_exp_f32 v85, v85
  s_nop 0
  v_add_f32 v85, 1.0, v85
  v_rcp_f32 v85, v85
  s_nop 0
  v_mul_f32 v85, v85, v152
  v_cvt_pk_bf16_f32 v85, v85, v85
  v_lshlrev_b32 v85, 16, v85
  v_mul_f32 v86, v85, v160
  v_cvt_pk_bf16_f32 v153, v153, v153
  v_lshlrev_b32 v153, 16, v153
  v_cvt_pk_bf16_f32 v161, v161, v161
  v_lshlrev_b32 v161, 16, v161
  v_mul_f32 v84, v153, v153
  v_mov_b32 v85, s38
  v_fmac_f32 v85, s39, v84
  v_mul_f32 v85, v85, v153
  v_exp_f32 v85, v85
  s_nop 0
  v_add_f32 v85, 1.0, v85
  v_rcp_f32 v85, v85
  s_nop 0
  v_mul_f32 v85, v85, v153
  v_cvt_pk_bf16_f32 v85, v85, v85
  v_lshlrev_b32 v85, 16, v85
  v_mul_f32 v87, v85, v161
  v_cvt_pk_bf16_f32 v154, v154, v154
  v_lshlrev_b32 v154, 16, v154
  v_cvt_pk_bf16_f32 v162, v162, v162
  v_lshlrev_b32 v162, 16, v162
  v_mul_f32 v84, v154, v154
  v_mov_b32 v85, s38
  v_fmac_f32 v85, s39, v84
  v_mul_f32 v85, v85, v154
  v_exp_f32 v85, v85
  s_nop 0
  v_add_f32 v85, 1.0, v85
  v_rcp_f32 v85, v85
  s_nop 0
  v_mul_f32 v85, v85, v154
  v_cvt_pk_bf16_f32 v85, v85, v85
  v_lshlrev_b32 v85, 16, v85
  v_mul_f32 v88, v85, v162
  v_cvt_pk_bf16_f32 v155, v155, v155
  v_lshlrev_b32 v155, 16, v155
  v_cvt_pk_bf16_f32 v163, v163, v163
  v_lshlrev_b32 v163, 16, v163
  v_mul_f32 v84, v155, v155
  v_mov_b32 v85, s38
  v_fmac_f32 v85, s39, v84
  v_mul_f32 v85, v85, v155
  v_exp_f32 v85, v85
  s_nop 0
  v_add_f32 v85, 1.0, v85
  v_rcp_f32 v85, v85
  s_nop 0
  v_mul_f32 v85, v85, v155
  v_cvt_pk_bf16_f32 v85, v85, v85
  v_lshlrev_b32 v85, 16, v85
  v_mul_f32 v89, v85, v163
  v_cvt_pk_bf16_f32 v84, v86, v87
  v_cvt_pk_bf16_f32 v85, v88, v89
  global_store_dwordx2 v8, v[84:85], s[36:37] offset:16
  s_nop 0
k1_nx3:
  s_mul_i32 s25, s21, 5
  s_add_u32 s25, s25, 4
  s_cmp_lt_u32 s25, 2
  s_cbranch_scc1 k1_pl4
  s_cmp_lt_u32 s15, 14
  s_cbranch_scc1 k1_ffn4
  s_sub_u32 s26, s25, 2
  s_lshr_b32 s27, s26, 2
  s_and_b32 s26, s26, 3
  s_lshl_b32 s27, s27, 3
  s_add_u32 s26, s26, s27
  s_add_u32 s26, s26, s43
  s_add_u32 s26, s26, 4
  s_add_u32 s27, s26, 4
  s_branch k1_q4
k1_pl4:
  s_lshl_b32 s26, s25, 1
  s_add_u32 s26, s26, s43
  s_add_u32 s27, s26, 1
k1_q4:
  s_lshl_b32 s26, s26, 16
  s_lshl_b32 s27, s27, 16
  s_add_u32 s28, s12, s26
  s_addc_u32 s29, s13, 0
  s_add_u32 s30, s12, s27
  s_addc_u32 s31, s13, 0
  v_cvt_pk_bf16_f32 v84, v164, v165
  v_cvt_pk_bf16_f32 v85, v166, v167
  global_store_dwordx2 v5, v[84:85], s[28:29] offset:0
  s_nop 0
  v_cvt_pk_bf16_f32 v84, v168, v169
  v_cvt_pk_bf16_f32 v85, v170, v171
  global_store_dwordx2 v5, v[84:85], s[28:29] offset:16
  s_nop 0
  v_cvt_pk_bf16_f32 v84, v172, v173
  v_cvt_pk_bf16_f32 v85, v174, v175
  global_store_dwordx2 v5, v[84:85], s[30:31] offset:0
  s_nop 0
  v_cvt_pk_bf16_f32 v84, v176, v177
  v_cvt_pk_bf16_f32 v85, v178, v179
  global_store_dwordx2 v5, v[84:85], s[30:31] offset:16
  s_nop 0
  s_branch k1_nx4
k1_ffn4:
  s_sub_u32 s26, s25, 2
  s_lshl_b32 s26, s26, 5
  s_lshl_b32 s27, s15, 8
  s_add_u32 s26, s26, s27
  v_add_u32 v8, s26, v7
  v_cvt_pk_bf16_f32 v164, v164, v164
  v_lshlrev_b32 v164, 16, v164
  v_cvt_pk_bf16_f32 v172, v172, v172
  v_lshlrev_b32 v172, 16, v172
  v_mul_f32 v84, v164, v164
  v_mov_b32 v85, s38
  v_fmac_f32 v85, s39, v84
  v_mul_f32 v85, v85, v164
  v_exp_f32 v85, v85
  s_nop 0
  v_add_f32 v85, 1.0, v85
  v_rcp_f32 v85, v85
  s_nop 0
  v_mul_f32 v85, v85, v164
  v_cvt_pk_bf16_f32 v85, v85, v85
  v_lshlrev_b32 v85, 16, v85
  v_mul_f32 v86, v85, v172
  v_cvt_pk_bf16_f32 v165, v165, v165
  v_lshlrev_b32 v165, 16, v165
  v_cvt_pk_bf16_f32 v173, v173, v173
  v_lshlrev_b32 v173, 16, v173
  v_mul_f32 v84, v165, v165
  v_mov_b32 v85, s38
  v_fmac_f32 v85, s39, v84
  v_mul_f32 v85, v85, v165
  v_exp_f32 v85, v85
  s_nop 0
  v_add_f32 v85, 1.0, v85
  v_rcp_f32 v85, v85
  s_nop 0
  v_mul_f32 v85, v85, v165
  v_cvt_pk_bf16_f32 v85, v85, v85
  v_lshlrev_b32 v85, 16, v85
  v_mul_f32 v87, v85, v173
  v_cvt_pk_bf16_f32 v166, v166, v166
  v_lshlrev_b32 v166, 16, v166
  v_cvt_pk_bf16_f32 v174, v174, v174
  v_lshlrev_b32 v174, 16, v174
  v_mul_f32 v84, v166, v166
  v_mov_b32 v85, s38
  v_fmac_f32 v85, s39, v84
  v_mul_f32 v85, v85, v166
  v_exp_f32 v85, v85
  s_nop 0
  v_add_f32 v85, 1.0, v85
  v_rcp_f32 v85, v85
  s_nop 0
  v_mul_f32 v85, v85, v166
  v_cvt_pk_bf16_f32 v85, v85, v85
  v_lshlrev_b32 v85, 16, v85
  v_mul_f32 v88, v85, v174
  v_cvt_pk_bf16_f32 v167, v167, v167
  v_lshlrev_b32 v167, 16, v167
  v_cvt_pk_bf16_f32 v175, v175, v175
  v_lshlrev_b32 v175, 16, v175
  v_mul_f32 v84, v167, v167
  v_mov_b32 v85, s38
  v_fmac_f32 v85, s39, v84
  v_mul_f32 v85, v85, v167
  v_exp_f32 v85, v85
  s_nop 0
  v_add_f32 v85, 1.0, v85
  v_rcp_f32 v85, v85
  s_nop 0
  v_mul_f32 v85, v85, v167
  v_cvt_pk_bf16_f32 v85, v85, v85
  v_lshlrev_b32 v85, 16, v85
  v_mul_f32 v89, v85, v175
  v_cvt_pk_bf16_f32 v84, v86, v87
  v_cvt_pk_bf16_f32 v85, v88, v89
  global_store_dwordx2 v8, v[84:85], s[36:37] offset:0
  s_nop 0
  v_cvt_pk_bf16_f32 v168, v168, v168
  v_lshlrev_b32 v168, 16, v168
  v_cvt_pk_bf16_f32 v176, v176, v176
  v_lshlrev_b32 v176, 16, v176
  v_mul_f32 v84, v168, v168
  v_mov_b32 v85, s38
  v_fmac_f32 v85, s39, v84
  v_mul_f32 v85, v85, v168
  v_exp_f32 v85, v85
  s_nop 0
  v_add_f32 v85, 1.0, v85
  v_rcp_f32 v85, v85
  s_nop 0
  v_mul_f32 v85, v85, v168
  v_cvt_pk_bf16_f32 v85, v85, v85
  v_lshlrev_b32 v85, 16, v85
  v_mul_f32 v86, v85, v176
  v_cvt_pk_bf16_f32 v169, v169, v169
  v_lshlrev_b32 v169, 16, v169
  v_cvt_pk_bf16_f32 v177, v177, v177
  v_lshlrev_b32 v177, 16, v177
  v_mul_f32 v84, v169, v169
  v_mov_b32 v85, s38
  v_fmac_f32 v85, s39, v84
  v_mul_f32 v85, v85, v169
  v_exp_f32 v85, v85
  s_nop 0
  v_add_f32 v85, 1.0, v85
  v_rcp_f32 v85, v85
  s_nop 0
  v_mul_f32 v85, v85, v169
  v_cvt_pk_bf16_f32 v85, v85, v85
  v_lshlrev_b32 v85, 16, v85
  v_mul_f32 v87, v85, v177
  v_cvt_pk_bf16_f32 v170, v170, v170
  v_lshlrev_b32 v170, 16, v170
  v_cvt_pk_bf16_f32 v178, v178, v178
  v_lshlrev_b32 v178, 16, v178
  v_mul_f32 v84, v170, v170
  v_mov_b32 v85, s38
  v_fmac_f32 v85, s39, v84
  v_mul_f32 v85, v85, v170
  v_exp_f32 v85, v85
  s_nop 0
  v_add_f32 v85, 1.0, v85
  v_rcp_f32 v85, v85
  s_nop 0
  v_mul_f32 v85, v85, v170
  v_cvt_pk_bf16_f32 v85, v85, v85
  v_lshlrev_b32 v85, 16, v85
  v_mul_f32 v88, v85, v178
  v_cvt_pk_bf16_f32 v171, v171, v171
  v_lshlrev_b32 v171, 16, v171
  v_cvt_pk_bf16_f32 v179, v179, v179
  v_lshlrev_b32 v179, 16, v179
  v_mul_f32 v84, v171, v171
  v_mov_b32 v85, s38
  v_fmac_f32 v85, s39, v84
  v_mul_f32 v85, v85, v171
  v_exp_f32 v85, v85
  s_nop 0
  v_add_f32 v85, 1.0, v85
  v_rcp_f32 v85, v85
  s_nop 0
  v_mul_f32 v85, v85, v171
  v_cvt_pk_bf16_f32 v85, v85, v85
  v_lshlrev_b32 v85, 16, v85
  v_mul_f32 v89, v85, v179
  v_cvt_pk_bf16_f32 v84, v86, v87
  v_cvt_pk_bf16_f32 v85, v88, v89
  global_store_dwordx2 v8, v[84:85], s[36:37] offset:16
  s_nop 0
k1_nx4:
k1_end:
  s_endpgm
.globl k2_kernel
.p2align 8
.type k2_kernel,@function
k2_kernel:
  s_cmp_ge_u32 s2, 512
  s_cbranch_scc1 k2_end
  s_load_dwordx2 s[12:13], s[0:1], 72
  s_lshr_b32 s14, s2, 4
  s_and_b32 s15, s2, 15
  v_and_b32 v1, 63, v0
  v_lshrrev_b32 v2, 6, v0
  s_nop 0
  v_readfirstlane_b32 s16, v2
  s_lshl_b32 s17, s15, 7
  s_lshl_b32 s18, s14, 11
  v_lshrrev_b32 v3, 1, v1
  v_and_b32 v4, 1, v1
  s_waitcnt lgkmcnt(0)
  s_add_u32 s20, s12, 2097152
  s_addc_u32 s21, s13, 0
  s_add_u32 s22, s12, 4194304
  s_addc_u32 s23, s13, 0
  s_add_u32 s24, s16, 0
  s_lshl_b32 s25, s24, 5
  s_add_u32 s25, s25, s17
  s_sub_u32 s25, s25, 256
  v_add_u32 v5, s25, v3
  v_max_i32 v5, 0, v5
  v_add_u32 v5, s18, v5
  v_lshlrev_b32 v5, 5, v5
  v_lshl_add_u32 v5, v4, 4, v5
  s_lshl_b32 m0, s24, 10
  s_nop 0
  global_load_lds_dwordx4 v5, s[20:21]
  s_lshl_b32 s24, s24, 10
  s_add_u32 m0, s24, 12288
  s_nop 0
  global_load_lds_dwordx4 v5, s[22:23]
  s_add_u32 s24, s16, 4
  s_lshl_b32 s25, s24, 5
  s_add_u32 s25, s25, s17
  s_sub_u32 s25, s25, 256
  v_add_u32 v5, s25, v3
  v_max_i32 v5, 0, v5
  v_add_u32 v5, s18, v5
  v_lshlrev_b32 v5, 5, v5
  v_lshl_add_u32 v5, v4, 4, v5
  s_lshl_b32 m0, s24, 10
  s_nop 0
  global_load_lds_dwordx4 v5, s[20:21]
  s_lshl_b32 s24, s24, 10
  s_add_u32 m0, s24, 12288
  s_nop 0
  global_load_lds_dwordx4 v5, s[22:23]
  s_add_u32 s24, s16, 8
  s_lshl_b32 s25, s24, 5
  s_add_u32 s25, s25, s17
  s_sub_u32 s25, s25, 256
  v_add_u32 v5, s25, v3
  v_max_i32 v5, 0, v5
  v_add_u32 v5, s18, v5
  v_lshlrev_b32 v5, 5, v5
  v_lshl_add_u32 v5, v4, 4, v5
  s_lshl_b32 m0, s24, 10
  s_nop 0
  global_load_lds_dwordx4 v5, s[20:21]
  s_lshl_b32 s24, s24, 10
  s_add_u32 m0, s24, 12288
  s_nop 0
  global_load_lds_dwordx4 v5, s[22:23]
  v_and_b32 v6, 31, v1
  v_lshrrev_b32 v7, 5, v1
  s_lshl_b32 s24, s16, 5
  s_add_u32 s25, s24, s17
  s_add_u32 s26, s25, s18
  v_add_u32 v8, s26, v6
  v_lshlrev_b32 v8, 5, v8
  v_lshl_add_u32 v8, v7, 4, v8
  global_load_dwordx4 v[56:59], v8, s[12:13]
  v_add_u32 v9, s24, v6
  v_lshlrev_b32 v9, 5, v9
  v_lshl_add_u32 v9, v7, 4, v9
  v_and_b32 v84, 15, v1
  v_lshrrev_b32 v85, 2, v84
  v_lshl_add_u32 v85, v7, 2, v85
  v_add_u32 v85, s24, v85
  v_lshlrev_b32 v85, 5, v85
  v_and_b32 v84, 3, v84
  v_lshl_add_u32 v10, v84, 3, v85
  v_add_u32 v10, 0x3000, v10
  v_lshlrev_b32 v84, 2, v7
  v_sub_u32 v11, v6, v84
  v_mov_b32 v12, 0xff800000
  s_lshr_b32 s27, s25, 5
  s_sub_u32 s27, 8, s27
  s_cmp_lt_u32 s25, 256
  s_cselect_b32 s27, s27, 0
  s_mov_b32 s28, 0x3eb8aa3b
  s_waitcnt vmcnt(0)
  s_barrier
  ds_read_b128 v[20:23], v9 offset:0
  ds_read_b128 v[24:27], v9 offset:1024
  ds_read_b128 v[28:31], v9 offset:2048
  ds_read_b128 v[32:35], v9 offset:3072
  ds_read_b128 v[36:39], v9 offset:4096
  ds_read_b128 v[40:43], v9 offset:5120
  ds_read_b128 v[44:47], v9 offset:6144
  ds_read_b128 v[48:51], v9 offset:7168
  ds_read_b128 v[52:55], v9 offset:8192
  s_waitcnt lgkmcnt(8)
  v_mfma_f32_32x32x16_bf16 v[100:115], v[20:23], v[56:59], 0
  s_waitcnt lgkmcnt(7)
  v_mfma_f32_32x32x16_bf16 v[116:131], v[24:27], v[56:59], 0
  s_waitcnt lgkmcnt(6)
  v_mfma_f32_32x32x16_bf16 v[132:147], v[28:31], v[56:59], 0
  s_waitcnt lgkmcnt(5)
  v_mfma_f32_32x32x16_bf16 v[148:163], v[32:35], v[56:59], 0
  s_waitcnt lgkmcnt(4)
  v_mfma_f32_32x32x16_bf16 v[164:179], v[36:39], v[56:59], 0
  s_waitcnt lgkmcnt(3)
  v_mfma_f32_32x32x16_bf16 v[180:195], v[40:43], v[56:59], 0
  s_waitcnt lgkmcnt(2)
  v_mfma_f32_32x32x16_bf16 v[196:211], v[44:47], v[56:59], 0
  s_waitcnt lgkmcnt(1)
  v_mfma_f32_32x32x16_bf16 v[212:227], v[48:51], v[56:59], 0
  s_waitcnt lgkmcnt(0)
  v_mfma_f32_32x32x16_bf16 v[228:243], v[52:55], v[56:59], 0
  s_nop 15
  v_cvt_pk_bf16_f32 v84, v100, v101
  v_lshlrev_b32 v100, 16, v84
  v_and_b32 v101, 0xffff0000, v84
  v_cvt_pk_bf16_f32 v84, v102, v103
  v_lshlrev_b32 v102, 16, v84
  v_and_b32 v103, 0xffff0000, v84
  v_cvt_pk_bf16_f32 v84, v104, v105
  v_lshlrev_b32 v104, 16, v84
  v_and_b32 v105, 0xffff0000, v84
  v_cvt_pk_bf16_f32 v84, v106, v107
  v_lshlrev_b32 v106, 16, v84
  v_and_b32 v107, 0xffff0000, v84
  v_cvt_pk_bf16_f32 v84, v108, v109
  v_lshlrev_b32 v108, 16, v84
  v_and_b32 v109, 0xffff0000, v84
  v_cvt_pk_bf16_f32 v84, v110, v111
  v_lshlrev_b32 v110, 16, v84
  v_and_b32 v111, 0xffff0000, v84
  v_cvt_pk_bf16_f32 v84, v112, v113
  v_lshlrev_b32 v112, 16, v84
  v_and_b32 v113, 0xffff0000, v84
  v_cvt_pk_bf16_f32 v84, v114, v115
  v_lshlrev_b32 v114, 16, v84
  v_and_b32 v115, 0xffff0000, v84
  v_cmp_gt_i32 s[40:41], 0, v11
  v_cmp_gt_i32 s[42:43], 1, v11
  v_cmp_gt_i32 s[44:45], 2, v11
  v_cmp_gt_i32 s[46:47], 3, v11
  v_cndmask_b32 v100, v12, v100, s[40:41]
  v_cndmask_b32 v101, v12, v101, s[42:43]
  v_cndmask_b32 v102, v12, v102, s[44:45]
  v_cndmask_b32 v103, v12, v103, s[46:47]
  v_cmp_gt_i32 s[40:41], 8, v11
  v_cmp_gt_i32 s[42:43], 9, v11
  v_cmp_gt_i32 s[44:45], 10, v11
  v_cmp_gt_i32 s[46:47], 11, v11
  v_cndmask_b32 v104, v12, v104, s[40:41]
  v_cndmask_b32 v105, v12, v105, s[42:43]
  v_cndmask_b32 v106, v12, v106, s[44:45]
  v_cndmask_b32 v107, v12, v107, s[46:47]
  v_cmp_gt_i32 s[40:41], 16, v11
  v_cmp_gt_i32 s[42:43], 17, v11
  v_cmp_gt_i32 s[44:45], 18, v11
  v_cmp_gt_i32 s[46:47], 19, v11
  v_cndmask_b32 v108, v12, v108, s[40:41]
  v_cndmask_b32 v109, v12, v109, s[42:43]
  v_cndmask_b32 v110, v12, v110, s[44:45]
  v_cndmask_b32 v111, v12, v111, s[46:47]
  v_cmp_gt_i32 s[40:41], 24, v11
  v_cmp_gt_i32 s[42:43], 25, v11
  v_cmp_gt_i32 s[44:45], 26, v11
  v_cmp_gt_i32 s[46:47], 27, v11
  v_cndmask_b32 v112, v12, v112, s[40:41]
  v_cndmask_b32 v113, v12, v113, s[42:43]
  v_cndmask_b32 v114, v12, v114, s[44:45]
  v_cndmask_b32 v115, v12, v115, s[46:47]
  s_cmp_lt_u32 0, s27
  s_cbranch_scc0 k2_sk0
  v_mov_b32 v100, v12
  v_mov_b32 v101, v12
  v_mov_b32 v102, v12
  v_mov_b32 v103, v12
  v_mov_b32 v104, v12
  v_mov_b32 v105, v12
  v_mov_b32 v106, v12
  v_mov_b32 v107, v12
  v_mov_b32 v108, v12
  v_mov_b32 v109, v12
  v_mov_b32 v110, v12
  v_mov_b32 v111, v12
  v_mov_b32 v112, v12
  v_mov_b32 v113, v12
  v_mov_b32 v114, v12
  v_mov_b32 v115, v12
k2_sk0:
  v_cvt_pk_bf16_f32 v84, v116, v117
  v_lshlrev_b32 v116, 16, v84
  v_and_b32 v117, 0xffff0000, v84
  v_cvt_pk_bf16_f32 v84, v118, v119
  v_lshlrev_b32 v118, 16, v84
  v_and_b32 v119, 0xffff0000, v84
  v_cvt_pk_bf16_f32 v84, v120, v121
  v_lshlrev_b32 v120, 16, v84
  v_and_b32 v121, 0xffff0000, v84
  v_cvt_pk_bf16_f32 v84, v122, v123
  v_lshlrev_b32 v122, 16, v84
  v_and_b32 v123, 0xffff0000, v84
  v_cvt_pk_bf16_f32 v84, v124, v125
  v_lshlrev_b32 v124, 16, v84
  v_and_b32 v125, 0xffff0000, v84
  v_cvt_pk_bf16_f32 v84, v126, v127
  v_lshlrev_b32 v126, 16, v84
  v_and_b32 v127, 0xffff0000, v84
  v_cvt_pk_bf16_f32 v84, v128, v129
  v_lshlrev_b32 v128, 16, v84
  v_and_b32 v129, 0xffff0000, v84
  v_cvt_pk_bf16_f32 v84, v130, v131
  v_lshlrev_b32 v130, 16, v84
  v_and_b32 v131, 0xffff0000, v84
  s_cmp_lt_u32 1, s27
  s_cbranch_scc0 k2_sk1
  v_mov_b32 v116, v12
  v_mov_b32 v117, v12
  v_mov_b32 v118, v12
  v_mov_b32 v119, v12
  v_mov_b32 v120, v12
  v_mov_b32 v121, v12
  v_mov_b32 v122, v12
  v_mov_b32 v123, v12
  v_mov_b32 v124, v12
  v_mov_b32 v125, v12
  v_mov_b32 v126, v12
  v_mov_b32 v127, v12
  v_mov_b32 v128, v12
  v_mov_b32 v129, v12
  v_mov_b32 v130, v12
  v_mov_b32 v131, v12
k2_sk1:
  v_cvt_pk_bf16_f32 v84, v132, v133
  v_lshlrev_b32 v132, 16, v84
  v_and_b32 v133, 0xffff0000, v84
  v_cvt_pk_bf16_f32 v84, v134, v135
  v_lshlrev_b32 v134, 16, v84
  v_and_b32 v135, 0xffff0000, v84
  v_cvt_pk_bf16_f32 v84, v136, v137
  v_lshlrev_b32 v136, 16, v84
  v_and_b32 v137, 0xffff0000, v84
  v_cvt_pk_bf16_f32 v84, v138, v139
  v_lshlrev_b32 v138, 16, v84
  v_and_b32 v139, 0xffff0000, v84
  v_cvt_pk_bf16_f32 v84, v140, v141
  v_lshlrev_b32 v140, 16, v84
  v_and_b32 v141, 0xffff0000, v84
  v_cvt_pk_bf16_f32 v84, v142, v143
  v_lshlrev_b32 v142, 16, v84
  v_and_b32 v143, 0xffff0000, v84
  v_cvt_pk_bf16_f32 v84, v144, v145
  v_lshlrev_b32 v144, 16, v84
  v_and_b32 v145, 0xffff0000, v84
  v_cvt_pk_bf16_f32 v84, v146, v147
  v_lshlrev_b32 v146, 16, v84
  v_and_b32 v147, 0xffff0000, v84
  s_cmp_lt_u32 2, s27
  s_cbranch_scc0 k2_sk2
  v_mov_b32 v132, v12
  v_mov_b32 v133, v12
  v_mov_b32 v134, v12
  v_mov_b32 v135, v12
  v_mov_b32 v136, v12
  v_mov_b32 v137, v12
  v_mov_b32 v138, v12
  v_mov_b32 v139, v12
  v_mov_b32 v140, v12
  v_mov_b32 v141, v12
  v_mov_b32 v142, v12
  v_mov_b32 v143, v12
  v_mov_b32 v144, v12
  v_mov_b32 v145, v12
  v_mov_b32 v146, v12
  v_mov_b32 v147, v12
k2_sk2:
  v_cvt_pk_bf16_f32 v84, v148, v149
  v_lshlrev_b32 v148, 16, v84
  v_and_b32 v149, 0xffff0000, v84
  v_cvt_pk_bf16_f32 v84, v150, v151
  v_lshlrev_b32 v150, 16, v84
  v_and_b32 v151, 0xffff0000, v84
  v_cvt_pk_bf16_f32 v84, v152, v153
  v_lshlrev_b32 v152, 16, v84
  v_and_b32 v153, 0xffff0000, v84
  v_cvt_pk_bf16_f32 v84, v154, v155
  v_lshlrev_b32 v154, 16, v84
  v_and_b32 v155, 0xffff0000, v84
  v_cvt_pk_bf16_f32 v84, v156, v157
  v_lshlrev_b32 v156, 16, v84
  v_and_b32 v157, 0xffff0000, v84
  v_cvt_pk_bf16_f32 v84, v158, v159
  v_lshlrev_b32 v158, 16, v84
  v_and_b32 v159, 0xffff0000, v84
  v_cvt_pk_bf16_f32 v84, v160, v161
  v_lshlrev_b32 v160, 16, v84
  v_and_b32 v161, 0xffff0000, v84
  v_cvt_pk_bf16_f32 v84, v162, v163
  v_lshlrev_b32 v162, 16, v84
  v_and_b32 v163, 0xffff0000, v84
  s_cmp_lt_u32 3, s27
  s_cbranch_scc0 k2_sk3
  v_mov_b32 v148, v12
  v_mov_b32 v149, v12
  v_mov_b32 v150, v12
  v_mov_b32 v151, v12
  v_mov_b32 v152, v12
  v_mov_b32 v153, v12
  v_mov_b32 v154, v12
  v_mov_b32 v155, v12
  v_mov_b32 v156, v12
  v_mov_b32 v157, v12
  v_mov_b32 v158, v12
  v_mov_b32 v159, v12
  v_mov_b32 v160, v12
  v_mov_b32 v161, v12
  v_mov_b32 v162, v12
  v_mov_b32 v163, v12
k2_sk3:
  v_cvt_pk_bf16_f32 v84, v164, v165
  v_lshlrev_b32 v164, 16, v84
  v_and_b32 v165, 0xffff0000, v84
  v_cvt_pk_bf16_f32 v84, v166, v167
  v_lshlrev_b32 v166, 16, v84
  v_and_b32 v167, 0xffff0000, v84
  v_cvt_pk_bf16_f32 v84, v168, v169
  v_lshlrev_b32 v168, 16, v84
  v_and_b32 v169, 0xffff0000, v84
  v_cvt_pk_bf16_f32 v84, v170, v171
  v_lshlrev_b32 v170, 16, v84
  v_and_b32 v171, 0xffff0000, v84
  v_cvt_pk_bf16_f32 v84, v172, v173
  v_lshlrev_b32 v172, 16, v84
  v_and_b32 v173, 0xffff0000, v84
  v_cvt_pk_bf16_f32 v84, v174, v175
  v_lshlrev_b32 v174, 16, v84
  v_and_b32 v175, 0xffff0000, v84
  v_cvt_pk_bf16_f32 v84, v176, v177
  v_lshlrev_b32 v176, 16, v84
  v_and_b32 v177, 0xffff0000, v84
  v_cvt_pk_bf16_f32 v84, v178, v179
  v_lshlrev_b32 v178, 16, v84
  v_and_b32 v179, 0xffff0000, v84
  s_cmp_lt_u32 4, s27
  s_cbranch_scc0 k2_sk4
  v_mov_b32 v164, v12
  v_mov_b32 v165, v12
  v_mov_b32 v166, v12
  v_mov_b32 v167, v12
  v_mov_b32 v168, v12
  v_mov_b32 v169, v12
  v_mov_b32 v170, v12
  v_mov_b32 v171, v12
  v_mov_b32 v172, v12
  v_mov_b32 v173, v12
  v_mov_b32 v174, v12
  v_mov_b32 v175, v12
  v_mov_b32 v176, v12
  v_mov_b32 v177, v12
  v_mov_b32 v178, v12
  v_mov_b32 v179, v12
k2_sk4:
  v_cvt_pk_bf16_f32 v84, v180, v181
  v_lshlrev_b32 v180, 16, v84
  v_and_b32 v181, 0xffff0000, v84
  v_cvt_pk_bf16_f32 v84, v182, v183
  v_lshlrev_b32 v182, 16, v84
  v_and_b32 v183, 0xffff0000, v84
  v_cvt_pk_bf16_f32 v84, v184, v185
  v_lshlrev_b32 v184, 16, v84
  v_and_b32 v185, 0xffff0000, v84
  v_cvt_pk_bf16_f32 v84, v186, v187
  v_lshlrev_b32 v186, 16, v84
  v_and_b32 v187, 0xffff0000, v84
  v_cvt_pk_bf16_f32 v84, v188, v189
  v_lshlrev_b32 v188, 16, v84
  v_and_b32 v189, 0xffff0000, v84
  v_cvt_pk_bf16_f32 v84, v190, v191
  v_lshlrev_b32 v190, 16, v84
  v_and_b32 v191, 0xffff0000, v84
  v_cvt_pk_bf16_f32 v84, v192, v193
  v_lshlrev_b32 v192, 16, v84
  v_and_b32 v193, 0xffff0000, v84
  v_cvt_pk_bf16_f32 v84, v194, v195
  v_lshlrev_b32 v194, 16, v84
  v_and_b32 v195, 0xffff0000, v84
  s_cmp_lt_u32 5, s27
  s_cbranch_scc0 k2_sk5
  v_mov_b32 v180, v12
  v_mov_b32 v181, v12
  v_mov_b32 v182, v12
  v_mov_b32 v183, v12
  v_mov_b32 v184, v12
  v_mov_b32 v185, v12
  v_mov_b32 v186, v12
  v_mov_b32 v187, v12
  v_mov_b32 v188, v12
  v_mov_b32 v189, v12
  v_mov_b32 v190, v12
  v_mov_b32 v191, v12
  v_mov_b32 v192, v12
  v_mov_b32 v193, v12
  v_mov_b32 v194, v12
  v_mov_b32 v195, v12
k2_sk5:
  v_cvt_pk_bf16_f32 v84, v196, v197
  v_lshlrev_b32 v196, 16, v84
  v_and_b32 v197, 0xffff0000, v84
  v_cvt_pk_bf16_f32 v84, v198, v199
  v_lshlrev_b32 v198, 16, v84
  v_and_b32 v199, 0xffff0000, v84
  v_cvt_pk_bf16_f32 v84, v200, v201
  v_lshlrev_b32 v200, 16, v84
  v_and_b32 v201, 0xffff0000, v84
  v_cvt_pk_bf16_f32 v84, v202, v203
  v_lshlrev_b32 v202, 16, v84
  v_and_b32 v203, 0xffff0000, v84
  v_cvt_pk_bf16_f32 v84, v204, v205
  v_lshlrev_b32 v204, 16, v84
  v_and_b32 v205, 0xffff0000, v84
  v_cvt_pk_bf16_f32 v84, v206, v207
  v_lshlrev_b32 v206, 16, v84
  v_and_b32 v207, 0xffff0000, v84
  v_cvt_pk_bf16_f32 v84, v208, v209
  v_lshlrev_b32 v208, 16, v84
  v_and_b32 v209, 0xffff0000, v84
  v_cvt_pk_bf16_f32 v84, v210, v211
  v_lshlrev_b32 v210, 16, v84
  v_and_b32 v211, 0xffff0000, v84
  s_cmp_lt_u32 6, s27
  s_cbranch_scc0 k2_sk6
  v_mov_b32 v196, v12
  v_mov_b32 v197, v12
  v_mov_b32 v198, v12
  v_mov_b32 v199, v12
  v_mov_b32 v200, v12
  v_mov_b32 v201, v12
  v_mov_b32 v202, v12
  v_mov_b32 v203, v12
  v_mov_b32 v204, v12
  v_mov_b32 v205, v12
  v_mov_b32 v206, v12
  v_mov_b32 v207, v12
  v_mov_b32 v208, v12
  v_mov_b32 v209, v12
  v_mov_b32 v210, v12
  v_mov_b32 v211, v12
k2_sk6:
  v_cvt_pk_bf16_f32 v84, v212, v213
  v_lshlrev_b32 v212, 16, v84
  v_and_b32 v213, 0xffff0000, v84
  v_cvt_pk_bf16_f32 v84, v214, v215
  v_lshlrev_b32 v214, 16, v84
  v_and_b32 v215, 0xffff0000, v84
  v_cvt_pk_bf16_f32 v84, v216, v217
  v_lshlrev_b32 v216, 16, v84
  v_and_b32 v217, 0xffff0000, v84
  v_cvt_pk_bf16_f32 v84, v218, v219
  v_lshlrev_b32 v218, 16, v84
  v_and_b32 v219, 0xffff0000, v84
  v_cvt_pk_bf16_f32 v84, v220, v221
  v_lshlrev_b32 v220, 16, v84
  v_and_b32 v221, 0xffff0000, v84
  v_cvt_pk_bf16_f32 v84, v222, v223
  v_lshlrev_b32 v222, 16, v84
  v_and_b32 v223, 0xffff0000, v84
  v_cvt_pk_bf16_f32 v84, v224, v225
  v_lshlrev_b32 v224, 16, v84
  v_and_b32 v225, 0xffff0000, v84
  v_cvt_pk_bf16_f32 v84, v226, v227
  v_lshlrev_b32 v226, 16, v84
  v_and_b32 v227, 0xffff0000, v84
  s_cmp_lt_u32 7, s27
  s_cbranch_scc0 k2_sk7
  v_mov_b32 v212, v12
  v_mov_b32 v213, v12
  v_mov_b32 v214, v12
  v_mov_b32 v215, v12
  v_mov_b32 v216, v12
  v_mov_b32 v217, v12
  v_mov_b32 v218, v12
  v_mov_b32 v219, v12
  v_mov_b32 v220, v12
  v_mov_b32 v221, v12
  v_mov_b32 v222, v12
  v_mov_b32 v223, v12
  v_mov_b32 v224, v12
  v_mov_b32 v225, v12
  v_mov_b32 v226, v12
  v_mov_b32 v227, v12
k2_sk7:
  v_cvt_pk_bf16_f32 v84, v228, v229
  v_lshlrev_b32 v228, 16, v84
  v_and_b32 v229, 0xffff0000, v84
  v_cvt_pk_bf16_f32 v84, v230, v231
  v_lshlrev_b32 v230, 16, v84
  v_and_b32 v231, 0xffff0000, v84
  v_cvt_pk_bf16_f32 v84, v232, v233
  v_lshlrev_b32 v232, 16, v84
  v_and_b32 v233, 0xffff0000, v84
  v_cvt_pk_bf16_f32 v84, v234, v235
  v_lshlrev_b32 v234, 16, v84
  v_and_b32 v235, 0xffff0000, v84
  v_cvt_pk_bf16_f32 v84, v236, v237
  v_lshlrev_b32 v236, 16, v84
  v_and_b32 v237, 0xffff0000, v84
  v_cvt_pk_bf16_f32 v84, v238, v239
  v_lshlrev_b32 v238, 16, v84
  v_and_b32 v239, 0xffff0000, v84
  v_cvt_pk_bf16_f32 v84, v240, v241
  v_lshlrev_b32 v240, 16, v84
  v_and_b32 v241, 0xffff0000, v84
  v_cvt_pk_bf16_f32 v84, v242, v243
  v_lshlrev_b32 v242, 16, v84
  v_and_b32 v243, 0xffff0000, v84
  v_cmp_le_i32 s[40:41], 0, v11
  v_cmp_le_i32 s[42:43], 1, v11
  v_cmp_le_i32 s[44:45], 2, v11
  v_cmp_le_i32 s[46:47], 3, v11
  v_cndmask_b32 v228, v12, v228, s[40:41]
  v_cndmask_b32 v229, v12, v229, s[42:43]
  v_cndmask_b32 v230, v12, v230, s[44:45]
  v_cndmask_b32 v231, v12, v231, s[46:47]
  v_cmp_le_i32 s[40:41], 8, v11
  v_cmp_le_i32 s[42:43], 9, v11
  v_cmp_le_i32 s[44:45], 10, v11
  v_cmp_le_i32 s[46:47], 11, v11
  v_cndmask_b32 v232, v12, v232, s[40:41]
  v_cndmask_b32 v233, v12, v233, s[42:43]
  v_cndmask_b32 v234, v12, v234, s[44:45]
  v_cndmask_b32 v235, v12, v235, s[46:47]
  v_cmp_le_i32 s[40:41], 16, v11
  v_cmp_le_i32 s[42:43], 17, v11
  v_cmp_le_i32 s[44:45], 18, v11
  v_cmp_le_i32 s[46:47], 19, v11
  v_cndmask_b32 v236, v12, v236, s[40:41]
  v_cndmask_b32 v237, v12, v237, s[42:43]
  v_cndmask_b32 v238, v12, v238, s[44:45]
  v_cndmask_b32 v239, v12, v239, s[46:47]
  v_cmp_le_i32 s[40:41], 24, v11
  v_cmp_le_i32 s[42:43], 25, v11
  v_cmp_le_i32 s[44:45], 26, v11
  v_cmp_le_i32 s[46:47], 27, v11
  v_cndmask_b32 v240, v12, v240, s[40:41]
  v_cndmask_b32 v241, v12, v241, s[42:43]
  v_cndmask_b32 v242, v12, v242, s[44:45]
  v_cndmask_b32 v243, v12, v243, s[46:47]
  v_max_f32 v84, v100, v101
  v_max3_f32 v84, v84, v102, v103
  v_max3_f32 v84, v84, v104, v105
  v_max3_f32 v84, v84, v106, v107
  v_max3_f32 v84, v84, v108, v109
  v_max3_f32 v84, v84, v110, v111
  v_max3_f32 v84, v84, v112, v113
  v_max3_f32 v84, v84, v114, v115
  v_max3_f32 v84, v84, v116, v117
  v_max3_f32 v84, v84, v118, v119
  v_max3_f32 v84, v84, v120, v121
  v_max3_f32 v84, v84, v122, v123
  v_max3_f32 v84, v84, v124, v125
  v_max3_f32 v84, v84, v126, v127
  v_max3_f32 v84, v84, v128, v129
  v_max3_f32 v84, v84, v130, v131
  v_max3_f32 v84, v84, v132, v133
  v_max3_f32 v84, v84, v134, v135
  v_max3_f32 v84, v84, v136, v137
  v_max3_f32 v84, v84, v138, v139
  v_max3_f32 v84, v84, v140, v141
  v_max3_f32 v84, v84, v142, v143
  v_max3_f32 v84, v84, v144, v145
  v_max3_f32 v84, v84, v146, v147
  v_max3_f32 v84, v84, v148, v149
  v_max3_f32 v84, v84, v150, v151
  v_max3_f32 v84, v84, v152, v153
  v_max3_f32 v84, v84, v154, v155
  v_max3_f32 v84, v84, v156, v157
  v_max3_f32 v84, v84, v158, v159
  v_max3_f32 v84, v84, v160, v161
  v_max3_f32 v84, v84, v162, v163
  v_max3_f32 v84, v84, v164, v165
  v_max3_f32 v84, v84, v166, v167
  v_max3_f32 v84, v84, v168, v169
  v_max3_f32 v84, v84, v170, v171
  v_max3_f32 v84, v84, v172, v173
  v_max3_f32 v84, v84, v174, v175
  v_max3_f32 v84, v84, v176, v177
  v_max3_f32 v84, v84, v178, v179
  v_max3_f32 v84, v84, v180, v181
  v_max3_f32 v84, v84, v182, v183
  v_max3_f32 v84, v84, v184, v185
  v_max3_f32 v84, v84, v186, v187
  v_max3_f32 v84, v84, v188, v189
  v_max3_f32 v84, v84, v190, v191
  v_max3_f32 v84, v84, v192, v193
  v_max3_f32 v84, v84, v194, v195
  v_max3_f32 v84, v84, v196, v197
  v_max3_f32 v84, v84, v198, v199
  v_max3_f32 v84, v84, v200, v201
  v_max3_f32 v84, v84, v202, v203
  v_max3_f32 v84, v84, v204, v205
  v_max3_f32 v84, v84, v206, v207
  v_max3_f32 v84, v84, v208, v209
  v_max3_f32 v84, v84, v210, v211
  v_max3_f32 v84, v84, v212, v213
  v_max3_f32 v84, v84, v214, v215
  v_max3_f32 v84, v84, v216, v217
  v_max3_f32 v84, v84, v218, v219
  v_max3_f32 v84, v84, v220, v221
  v_max3_f32 v84, v84, v222, v223
  v_max3_f32 v84, v84, v224, v225
  v_max3_f32 v84, v84, v226, v227
  v_max3_f32 v84, v84, v228, v229
  v_max3_f32 v84, v84, v230, v231
  v_max3_f32 v84, v84, v232, v233
  v_max3_f32 v84, v84, v234, v235
  v_max3_f32 v84, v84, v236, v237
  v_max3_f32 v84, v84, v238, v239
  v_max3_f32 v84, v84, v240, v241
  v_max3_f32 v84, v84, v242, v243
  v_mov_b32 v85, v84
  s_nop 1
  v_permlane32_swap_b32 v84, v85
  v_max_f32 v84, v84, v85
  v_mul_f32 v84, s28, v84
  v_mov_b32 v86, 0
  v_mov_b32 v87, 0
  v_fma_f32 v100, v100, s28, -v84
  v_exp_f32 v100, v100
  v_fma_f32 v101, v101, s28, -v84
  v_exp_f32 v101, v101
  v_fma_f32 v102, v102, s28, -v84
  v_exp_f32 v102, v102
  v_fma_f32 v103, v103, s28, -v84
  v_exp_f32 v103, v103
  v_fma_f32 v104, v104, s28, -v84
  v_exp_f32 v104, v104
  v_fma_f32 v105, v105, s28, -v84
  v_exp_f32 v105, v105
  v_fma_f32 v106, v106, s28, -v84
  v_exp_f32 v106, v106
  v_fma_f32 v107, v107, s28, -v84
  v_exp_f32 v107, v107
  v_fma_f32 v108, v108, s28, -v84
  v_exp_f32 v108, v108
  v_fma_f32 v109, v109, s28, -v84
  v_exp_f32 v109, v109
  v_fma_f32 v110, v110, s28, -v84
  v_exp_f32 v110, v110
  v_fma_f32 v111, v111, s28, -v84
  v_exp_f32 v111, v111
  v_fma_f32 v112, v112, s28, -v84
  v_exp_f32 v112, v112
  v_fma_f32 v113, v113, s28, -v84
  v_exp_f32 v113, v113
  v_fma_f32 v114, v114, s28, -v84
  v_exp_f32 v114, v114
  v_fma_f32 v115, v115, s28, -v84
  v_exp_f32 v115, v115
  v_fma_f32 v116, v116, s28, -v84
  v_exp_f32 v116, v116
  v_fma_f32 v117, v117, s28, -v84
  v_exp_f32 v117, v117
  v_fma_f32 v118, v118, s28, -v84
  v_exp_f32 v118, v118
  v_fma_f32 v119, v119, s28, -v84
  v_exp_f32 v119, v119
  v_fma_f32 v120, v120, s28, -v84
  v_exp_f32 v120, v120
  v_fma_f32 v121, v121, s28, -v84
  v_exp_f32 v121, v121
  v_fma_f32 v122, v122, s28, -v84
  v_exp_f32 v122, v122
  v_fma_f32 v123, v123, s28, -v84
  v_exp_f32 v123, v123
  v_fma_f32 v124, v124, s28, -v84
  v_exp_f32 v124, v124
  v_fma_f32 v125, v125, s28, -v84
  v_exp_f32 v125, v125
  v_fma_f32 v126, v126, s28, -v84
  v_exp_f32 v126, v126
  v_fma_f32 v127, v127, s28, -v84
  v_exp_f32 v127, v127
  v_fma_f32 v128, v128, s28, -v84
  v_exp_f32 v128, v128
  v_fma_f32 v129, v129, s28, -v84
  v_exp_f32 v129, v129
  v_fma_f32 v130, v130, s28, -v84
  v_exp_f32 v130, v130
  v_fma_f32 v131, v131, s28, -v84
  v_exp_f32 v131, v131
  v_fma_f32 v132, v132, s28, -v84
  v_exp_f32 v132, v132
  v_fma_f32 v133, v133, s28, -v84
  v_exp_f32 v133, v133
  v_fma_f32 v134, v134, s28, -v84
  v_exp_f32 v134, v134
  v_fma_f32 v135, v135, s28, -v84
  v_exp_f32 v135, v135
  v_fma_f32 v136, v136, s28, -v84
  v_exp_f32 v136, v136
  v_fma_f32 v137, v137, s28, -v84
  v_exp_f32 v137, v137
  v_fma_f32 v138, v138, s28, -v84
  v_exp_f32 v138, v138
  v_fma_f32 v139, v139, s28, -v84
  v_exp_f32 v139, v139
  v_fma_f32 v140, v140, s28, -v84
  v_exp_f32 v140, v140
  v_fma_f32 v141, v141, s28, -v84
  v_exp_f32 v141, v141
  v_fma_f32 v142, v142, s28, -v84
  v_exp_f32 v142, v142
  v_fma_f32 v143, v143, s28, -v84
  v_exp_f32 v143, v143
  v_fma_f32 v144, v144, s28, -v84
  v_exp_f32 v144, v144
  v_fma_f32 v145, v145, s28, -v84
  v_exp_f32 v145, v145
  v_fma_f32 v146, v146, s28, -v84
  v_exp_f32 v146, v146
  v_fma_f32 v147, v147, s28, -v84
  v_exp_f32 v147, v147
  v_fma_f32 v148, v148, s28, -v84
  v_exp_f32 v148, v148
  v_fma_f32 v149, v149, s28, -v84
  v_exp_f32 v149, v149
  v_fma_f32 v150, v150, s28, -v84
  v_exp_f32 v150, v150
  v_fma_f32 v151, v151, s28, -v84
  v_exp_f32 v151, v151
  v_fma_f32 v152, v152, s28, -v84
  v_exp_f32 v152, v152
  v_fma_f32 v153, v153, s28, -v84
  v_exp_f32 v153, v153
  v_fma_f32 v154, v154, s28, -v84
  v_exp_f32 v154, v154
  v_fma_f32 v155, v155, s28, -v84
  v_exp_f32 v155, v155
  v_fma_f32 v156, v156, s28, -v84
  v_exp_f32 v156, v156
  v_fma_f32 v157, v157, s28, -v84
  v_exp_f32 v157, v157
  v_fma_f32 v158, v158, s28, -v84
  v_exp_f32 v158, v158
  v_fma_f32 v159, v159, s28, -v84
  v_exp_f32 v159, v159
  v_fma_f32 v160, v160, s28, -v84
  v_exp_f32 v160, v160
  v_fma_f32 v161, v161, s28, -v84
  v_exp_f32 v161, v161
  v_fma_f32 v162, v162, s28, -v84
  v_exp_f32 v162, v162
  v_fma_f32 v163, v163, s28, -v84
  v_exp_f32 v163, v163
  v_fma_f32 v164, v164, s28, -v84
  v_exp_f32 v164, v164
  v_fma_f32 v165, v165, s28, -v84
  v_exp_f32 v165, v165
  v_fma_f32 v166, v166, s28, -v84
  v_exp_f32 v166, v166
  v_fma_f32 v167, v167, s28, -v84
  v_exp_f32 v167, v167
  v_fma_f32 v168, v168, s28, -v84
  v_exp_f32 v168, v168
  v_fma_f32 v169, v169, s28, -v84
  v_exp_f32 v169, v169
  v_fma_f32 v170, v170, s28, -v84
  v_exp_f32 v170, v170
  v_fma_f32 v171, v171, s28, -v84
  v_exp_f32 v171, v171
  v_fma_f32 v172, v172, s28, -v84
  v_exp_f32 v172, v172
  v_fma_f32 v173, v173, s28, -v84
  v_exp_f32 v173, v173
  v_fma_f32 v174, v174, s28, -v84
  v_exp_f32 v174, v174
  v_fma_f32 v175, v175, s28, -v84
  v_exp_f32 v175, v175
  v_fma_f32 v176, v176, s28, -v84
  v_exp_f32 v176, v176
  v_fma_f32 v177, v177, s28, -v84
  v_exp_f32 v177, v177
  v_fma_f32 v178, v178, s28, -v84
  v_exp_f32 v178, v178
  v_fma_f32 v179, v179, s28, -v84
  v_exp_f32 v179, v179
  v_fma_f32 v180, v180, s28, -v84
  v_exp_f32 v180, v180
  v_fma_f32 v181, v181, s28, -v84
  v_exp_f32 v181, v181
  v_fma_f32 v182, v182, s28, -v84
  v_exp_f32 v182, v182
  v_fma_f32 v183, v183, s28, -v84
  v_exp_f32 v183, v183
  v_fma_f32 v184, v184, s28, -v84
  v_exp_f32 v184, v184
  v_fma_f32 v185, v185, s28, -v84
  v_exp_f32 v185, v185
  v_fma_f32 v186, v186, s28, -v84
  v_exp_f32 v186, v186
  v_fma_f32 v187, v187, s28, -v84
  v_exp_f32 v187, v187
  v_fma_f32 v188, v188, s28, -v84
  v_exp_f32 v188, v188
  v_fma_f32 v189, v189, s28, -v84
  v_exp_f32 v189, v189
  v_fma_f32 v190, v190, s28, -v84
  v_exp_f32 v190, v190
  v_fma_f32 v191, v191, s28, -v84
  v_exp_f32 v191, v191
  v_fma_f32 v192, v192, s28, -v84
  v_exp_f32 v192, v192
  v_fma_f32 v193, v193, s28, -v84
  v_exp_f32 v193, v193
  v_fma_f32 v194, v194, s28, -v84
  v_exp_f32 v194, v194
  v_fma_f32 v195, v195, s28, -v84
  v_exp_f32 v195, v195
  v_fma_f32 v196, v196, s28, -v84
  v_exp_f32 v196, v196
  v_fma_f32 v197, v197, s28, -v84
  v_exp_f32 v197, v197
  v_fma_f32 v198, v198, s28, -v84
  v_exp_f32 v198, v198
  v_fma_f32 v199, v199, s28, -v84
  v_exp_f32 v199, v199
  v_fma_f32 v200, v200, s28, -v84
  v_exp_f32 v200, v200
  v_fma_f32 v201, v201, s28, -v84
  v_exp_f32 v201, v201
  v_fma_f32 v202, v202, s28, -v84
  v_exp_f32 v202, v202
  v_fma_f32 v203, v203, s28, -v84
  v_exp_f32 v203, v203
  v_fma_f32 v204, v204, s28, -v84
  v_exp_f32 v204, v204
  v_fma_f32 v205, v205, s28, -v84
  v_exp_f32 v205, v205
  v_fma_f32 v206, v206, s28, -v84
  v_exp_f32 v206, v206
  v_fma_f32 v207, v207, s28, -v84
  v_exp_f32 v207, v207
  v_fma_f32 v208, v208, s28, -v84
  v_exp_f32 v208, v208
  v_fma_f32 v209, v209, s28, -v84
  v_exp_f32 v209, v209
  v_fma_f32 v210, v210, s28, -v84
  v_exp_f32 v210, v210
  v_fma_f32 v211, v211, s28, -v84
  v_exp_f32 v211, v211
  v_fma_f32 v212, v212, s28, -v84
  v_exp_f32 v212, v212
  v_fma_f32 v213, v213, s28, -v84
  v_exp_f32 v213, v213
  v_fma_f32 v214, v214, s28, -v84
  v_exp_f32 v214, v214
  v_fma_f32 v215, v215, s28, -v84
  v_exp_f32 v215, v215
  v_fma_f32 v216, v216, s28, -v84
  v_exp_f32 v216, v216
  v_fma_f32 v217, v217, s28, -v84
  v_exp_f32 v217, v217
  v_fma_f32 v218, v218, s28, -v84
  v_exp_f32 v218, v218
  v_fma_f32 v219, v219, s28, -v84
  v_exp_f32 v219, v219
  v_fma_f32 v220, v220, s28, -v84
  v_exp_f32 v220, v220
  v_fma_f32 v221, v221, s28, -v84
  v_exp_f32 v221, v221
  v_fma_f32 v222, v222, s28, -v84
  v_exp_f32 v222, v222
  v_fma_f32 v223, v223, s28, -v84
  v_exp_f32 v223, v223
  v_fma_f32 v224, v224, s28, -v84
  v_exp_f32 v224, v224
  v_fma_f32 v225, v225, s28, -v84
  v_exp_f32 v225, v225
  v_fma_f32 v226, v226, s28, -v84
  v_exp_f32 v226, v226
  v_fma_f32 v227, v227, s28, -v84
  v_exp_f32 v227, v227
  v_fma_f32 v228, v228, s28, -v84
  v_exp_f32 v228, v228
  v_fma_f32 v229, v229, s28, -v84
  v_exp_f32 v229, v229
  v_fma_f32 v230, v230, s28, -v84
  v_exp_f32 v230, v230
  v_fma_f32 v231, v231, s28, -v84
  v_exp_f32 v231, v231
  v_fma_f32 v232, v232, s28, -v84
  v_exp_f32 v232, v232
  v_fma_f32 v233, v233, s28, -v84
  v_exp_f32 v233, v233
  v_fma_f32 v234, v234, s28, -v84
  v_exp_f32 v234, v234
  v_fma_f32 v235, v235, s28, -v84
  v_exp_f32 v235, v235
  v_fma_f32 v236, v236, s28, -v84
  v_exp_f32 v236, v236
  v_fma_f32 v237, v237, s28, -v84
  v_exp_f32 v237, v237
  v_fma_f32 v238, v238, s28, -v84
  v_exp_f32 v238, v238
  v_fma_f32 v239, v239, s28, -v84
  v_exp_f32 v239, v239
  v_fma_f32 v240, v240, s28, -v84
  v_exp_f32 v240, v240
  v_fma_f32 v241, v241, s28, -v84
  v_exp_f32 v241, v241
  v_fma_f32 v242, v242, s28, -v84
  v_exp_f32 v242, v242
  v_fma_f32 v243, v243, s28, -v84
  v_exp_f32 v243, v243
  s_nop 0
  v_add_f32 v86, v86, v100
  v_add_f32 v87, v87, v101
  v_add_f32 v86, v86, v102
  v_add_f32 v87, v87, v103
  v_add_f32 v86, v86, v104
  v_add_f32 v87, v87, v105
  v_add_f32 v86, v86, v106
  v_add_f32 v87, v87, v107
  v_add_f32 v86, v86, v108
  v_add_f32 v87, v87, v109
  v_add_f32 v86, v86, v110
  v_add_f32 v87, v87, v111
  v_add_f32 v86, v86, v112
  v_add_f32 v87, v87, v113
  v_add_f32 v86, v86, v114
  v_add_f32 v87, v87, v115
  v_add_f32 v86, v86, v116
  v_add_f32 v87, v87, v117
  v_add_f32 v86, v86, v118
  v_add_f32 v87, v87, v119
  v_add_f32 v86, v86, v120
  v_add_f32 v87, v87, v121
  v_add_f32 v86, v86, v122
  v_add_f32 v87, v87, v123
  v_add_f32 v86, v86, v124
  v_add_f32 v87, v87, v125
  v_add_f32 v86, v86, v126
  v_add_f32 v87, v87, v127
  v_add_f32 v86, v86, v128
  v_add_f32 v87, v87, v129
  v_add_f32 v86, v86, v130
  v_add_f32 v87, v87, v131
  v_add_f32 v86, v86, v132
  v_add_f32 v87, v87, v133
  v_add_f32 v86, v86, v134
  v_add_f32 v87, v87, v135
  v_add_f32 v86, v86, v136
  v_add_f32 v87, v87, v137
  v_add_f32 v86, v86, v138
  v_add_f32 v87, v87, v139
  v_add_f32 v86, v86, v140
  v_add_f32 v87, v87, v141
  v_add_f32 v86, v86, v142
  v_add_f32 v87, v87, v143
  v_add_f32 v86, v86, v144
  v_add_f32 v87, v87, v145
  v_add_f32 v86, v86, v146
  v_add_f32 v87, v87, v147
  v_add_f32 v86, v86, v148
  v_add_f32 v87, v87, v149
  v_add_f32 v86, v86, v150
  v_add_f32 v87, v87, v151
  v_add_f32 v86, v86, v152
  v_add_f32 v87, v87, v153
  v_add_f32 v86, v86, v154
  v_add_f32 v87, v87, v155
  v_add_f32 v86, v86, v156
  v_add_f32 v87, v87, v157
  v_add_f32 v86, v86, v158
  v_add_f32 v87, v87, v159
  v_add_f32 v86, v86, v160
  v_add_f32 v87, v87, v161
  v_add_f32 v86, v86, v162
  v_add_f32 v87, v87, v163
  v_add_f32 v86, v86, v164
  v_add_f32 v87, v87, v165
  v_add_f32 v86, v86, v166
  v_add_f32 v87, v87, v167
  v_add_f32 v86, v86, v168
  v_add_f32 v87, v87, v169
  v_add_f32 v86, v86, v170
  v_add_f32 v87, v87, v171
  v_add_f32 v86, v86, v172
  v_add_f32 v87, v87, v173
  v_add_f32 v86, v86, v174
  v_add_f32 v87, v87, v175
  v_add_f32 v86, v86, v176
  v_add_f32 v87, v87, v177
  v_add_f32 v86, v86, v178
  v_add_f32 v87, v87, v179
  v_add_f32 v86, v86, v180
  v_add_f32 v87, v87, v181
  v_add_f32 v86, v86, v182
  v_add_f32 v87, v87, v183
  v_add_f32 v86, v86, v184
  v_add_f32 v87, v87, v185
  v_add_f32 v86, v86, v186
  v_add_f32 v87, v87, v187
  v_add_f32 v86, v86, v188
  v_add_f32 v87, v87, v189
  v_add_f32 v86, v86, v190
  v_add_f32 v87, v87, v191
  v_add_f32 v86, v86, v192
  v_add_f32 v87, v87, v193
  v_add_f32 v86, v86, v194
  v_add_f32 v87, v87, v195
  v_add_f32 v86, v86, v196
  v_add_f32 v87, v87, v197
  v_add_f32 v86, v86, v198
  v_add_f32 v87, v87, v199
  v_add_f32 v86, v86, v200
  v_add_f32 v87, v87, v201
  v_add_f32 v86, v86, v202
  v_add_f32 v87, v87, v203
  v_add_f32 v86, v86, v204
  v_add_f32 v87, v87, v205
  v_add_f32 v86, v86, v206
  v_add_f32 v87, v87, v207
  v_add_f32 v86, v86, v208
  v_add_f32 v87, v87, v209
  v_add_f32 v86, v86, v210
  v_add_f32 v87, v87, v211
  v_add_f32 v86, v86, v212
  v_add_f32 v87, v87, v213
  v_add_f32 v86, v86, v214
  v_add_f32 v87, v87, v215
  v_add_f32 v86, v86, v216
  v_add_f32 v87, v87, v217
  v_add_f32 v86, v86, v218
  v_add_f32 v87, v87, v219
  v_add_f32 v86, v86, v220
  v_add_f32 v87, v87, v221
  v_add_f32 v86, v86, v222
  v_add_f32 v87, v87, v223
  v_add_f32 v86, v86, v224
  v_add_f32 v87, v87, v225
  v_add_f32 v86, v86, v226
  v_add_f32 v87, v87, v227
  v_add_f32 v86, v86, v228
  v_add_f32 v87, v87, v229
  v_add_f32 v86, v86, v230
  v_add_f32 v87, v87, v231
  v_add_f32 v86, v86, v232
  v_add_f32 v87, v87, v233
  v_add_f32 v86, v86, v234
  v_add_f32 v87, v87, v235
  v_add_f32 v86, v86, v236
  v_add_f32 v87, v87, v237
  v_add_f32 v86, v86, v238
  v_add_f32 v87, v87, v239
  v_add_f32 v86, v86, v240
  v_add_f32 v87, v87, v241
  v_add_f32 v86, v86, v242
  v_add_f32 v87, v87, v243
  v_add_f32 v86, v86, v87
  v_mov_b32 v85, v86
  s_nop 1
  v_permlane32_swap_b32 v86, v85
  v_add_f32 v86, v86, v85
  v_rcp_f32 v86, v86
  s_nop 0
  v_mul_f32 v100, v100, v86
  v_mul_f32 v101, v101, v86
  v_cvt_pk_bf16_f32 v100, v100, v101
  v_mul_f32 v102, v102, v86
  v_mul_f32 v103, v103, v86
  v_cvt_pk_bf16_f32 v101, v102, v103
  v_mul_f32 v104, v104, v86
  v_mul_f32 v105, v105, v86
  v_cvt_pk_bf16_f32 v102, v104, v105
  v_mul_f32 v106, v106, v86
  v_mul_f32 v107, v107, v86
  v_cvt_pk_bf16_f32 v103, v106, v107
  v_mul_f32 v108, v108, v86
  v_mul_f32 v109, v109, v86
  v_cvt_pk_bf16_f32 v104, v108, v109
  v_mul_f32 v110, v110, v86
  v_mul_f32 v111, v111, v86
  v_cvt_pk_bf16_f32 v105, v110, v111
  v_mul_f32 v112, v112, v86
  v_mul_f32 v113, v113, v86
  v_cvt_pk_bf16_f32 v106, v112, v113
  v_mul_f32 v114, v114, v86
  v_mul_f32 v115, v115, v86
  v_cvt_pk_bf16_f32 v107, v114, v115
  v_mul_f32 v116, v116, v86
  v_mul_f32 v117, v117, v86
  v_cvt_pk_bf16_f32 v108, v116, v117
  v_mul_f32 v118, v118, v86
  v_mul_f32 v119, v119, v86
  v_cvt_pk_bf16_f32 v109, v118, v119
  v_mul_f32 v120, v120, v86
  v_mul_f32 v121, v121, v86
  v_cvt_pk_bf16_f32 v110, v120, v121
  v_mul_f32 v122, v122, v86
  v_mul_f32 v123, v123, v86
  v_cvt_pk_bf16_f32 v111, v122, v123
  v_mul_f32 v124, v124, v86
  v_mul_f32 v125, v125, v86
  v_cvt_pk_bf16_f32 v112, v124, v125
  v_mul_f32 v126, v126, v86
  v_mul_f32 v127, v127, v86
  v_cvt_pk_bf16_f32 v113, v126, v127
  v_mul_f32 v128, v128, v86
  v_mul_f32 v129, v129, v86
  v_cvt_pk_bf16_f32 v114, v128, v129
  v_mul_f32 v130, v130, v86
  v_mul_f32 v131, v131, v86
  v_cvt_pk_bf16_f32 v115, v130, v131
  v_mul_f32 v132, v132, v86
  v_mul_f32 v133, v133, v86
  v_cvt_pk_bf16_f32 v116, v132, v133
  v_mul_f32 v134, v134, v86
  v_mul_f32 v135, v135, v86
  v_cvt_pk_bf16_f32 v117, v134, v135
  v_mul_f32 v136, v136, v86
  v_mul_f32 v137, v137, v86
  v_cvt_pk_bf16_f32 v118, v136, v137
  v_mul_f32 v138, v138, v86
  v_mul_f32 v139, v139, v86
  v_cvt_pk_bf16_f32 v119, v138, v139
  v_mul_f32 v140, v140, v86
  v_mul_f32 v141, v141, v86
  v_cvt_pk_bf16_f32 v120, v140, v141
  v_mul_f32 v142, v142, v86
  v_mul_f32 v143, v143, v86
  v_cvt_pk_bf16_f32 v121, v142, v143
  v_mul_f32 v144, v144, v86
  v_mul_f32 v145, v145, v86
  v_cvt_pk_bf16_f32 v122, v144, v145
  v_mul_f32 v146, v146, v86
  v_mul_f32 v147, v147, v86
  v_cvt_pk_bf16_f32 v123, v146, v147
  v_mul_f32 v148, v148, v86
  v_mul_f32 v149, v149, v86
  v_cvt_pk_bf16_f32 v124, v148, v149
  v_mul_f32 v150, v150, v86
  v_mul_f32 v151, v151, v86
  v_cvt_pk_bf16_f32 v125, v150, v151
  v_mul_f32 v152, v152, v86
  v_mul_f32 v153, v153, v86
  v_cvt_pk_bf16_f32 v126, v152, v153
  v_mul_f32 v154, v154, v86
  v_mul_f32 v155, v155, v86
  v_cvt_pk_bf16_f32 v127, v154, v155
  v_mul_f32 v156, v156, v86
  v_mul_f32 v157, v157, v86
  v_cvt_pk_bf16_f32 v128, v156, v157
  v_mul_f32 v158, v158, v86
  v_mul_f32 v159, v159, v86
  v_cvt_pk_bf16_f32 v129, v158, v159
  v_mul_f32 v160, v160, v86
  v_mul_f32 v161, v161, v86
  v_cvt_pk_bf16_f32 v130, v160, v161
  v_mul_f32 v162, v162, v86
  v_mul_f32 v163, v163, v86
  v_cvt_pk_bf16_f32 v131, v162, v163
  v_mul_f32 v164, v164, v86
  v_mul_f32 v165, v165, v86
  v_cvt_pk_bf16_f32 v132, v164, v165
  v_mul_f32 v166, v166, v86
  v_mul_f32 v167, v167, v86
  v_cvt_pk_bf16_f32 v133, v166, v167
  v_mul_f32 v168, v168, v86
  v_mul_f32 v169, v169, v86
  v_cvt_pk_bf16_f32 v134, v168, v169
  v_mul_f32 v170, v170, v86
  v_mul_f32 v171, v171, v86
  v_cvt_pk_bf16_f32 v135, v170, v171
  v_mul_f32 v172, v172, v86
  v_mul_f32 v173, v173, v86
  v_cvt_pk_bf16_f32 v136, v172, v173
  v_mul_f32 v174, v174, v86
  v_mul_f32 v175, v175, v86
  v_cvt_pk_bf16_f32 v137, v174, v175
  v_mul_f32 v176, v176, v86
  v_mul_f32 v177, v177, v86
  v_cvt_pk_bf16_f32 v138, v176, v177
  v_mul_f32 v178, v178, v86
  v_mul_f32 v179, v179, v86
  v_cvt_pk_bf16_f32 v139, v178, v179
  v_mul_f32 v180, v180, v86
  v_mul_f32 v181, v181, v86
  v_cvt_pk_bf16_f32 v140, v180, v181
  v_mul_f32 v182, v182, v86
  v_mul_f32 v183, v183, v86
  v_cvt_pk_bf16_f32 v141, v182, v183
  v_mul_f32 v184, v184, v86
  v_mul_f32 v185, v185, v86
  v_cvt_pk_bf16_f32 v142, v184, v185
  v_mul_f32 v186, v186, v86
  v_mul_f32 v187, v187, v86
  v_cvt_pk_bf16_f32 v143, v186, v187
  v_mul_f32 v188, v188, v86
  v_mul_f32 v189, v189, v86
  v_cvt_pk_bf16_f32 v144, v188, v189
  v_mul_f32 v190, v190, v86
  v_mul_f32 v191, v191, v86
  v_cvt_pk_bf16_f32 v145, v190, v191
  v_mul_f32 v192, v192, v86
  v_mul_f32 v193, v193, v86
  v_cvt_pk_bf16_f32 v146, v192, v193
  v_mul_f32 v194, v194, v86
  v_mul_f32 v195, v195, v86
  v_cvt_pk_bf16_f32 v147, v194, v195
  v_mul_f32 v196, v196, v86
  v_mul_f32 v197, v197, v86
  v_cvt_pk_bf16_f32 v148, v196, v197
  v_mul_f32 v198, v198, v86
  v_mul_f32 v199, v199, v86
  v_cvt_pk_bf16_f32 v149, v198, v199
  v_mul_f32 v200, v200, v86
  v_mul_f32 v201, v201, v86
  v_cvt_pk_bf16_f32 v150, v200, v201
  v_mul_f32 v202, v202, v86
  v_mul_f32 v203, v203, v86
  v_cvt_pk_bf16_f32 v151, v202, v203
  v_mul_f32 v204, v204, v86
  v_mul_f32 v205, v205, v86
  v_cvt_pk_bf16_f32 v152, v204, v205
  v_mul_f32 v206, v206, v86
  v_mul_f32 v207, v207, v86
  v_cvt_pk_bf16_f32 v153, v206, v207
  v_mul_f32 v208, v208, v86
  v_mul_f32 v209, v209, v86
  v_cvt_pk_bf16_f32 v154, v208, v209
  v_mul_f32 v210, v210, v86
  v_mul_f32 v211, v211, v86
  v_cvt_pk_bf16_f32 v155, v210, v211
  v_mul_f32 v212, v212, v86
  v_mul_f32 v213, v213, v86
  v_cvt_pk_bf16_f32 v156, v212, v213
  v_mul_f32 v214, v214, v86
  v_mul_f32 v215, v215, v86
  v_cvt_pk_bf16_f32 v157, v214, v215
  v_mul_f32 v216, v216, v86
  v_mul_f32 v217, v217, v86
  v_cvt_pk_bf16_f32 v158, v216, v217
  v_mul_f32 v218, v218, v86
  v_mul_f32 v219, v219, v86
  v_cvt_pk_bf16_f32 v159, v218, v219
  v_mul_f32 v220, v220, v86
  v_mul_f32 v221, v221, v86
  v_cvt_pk_bf16_f32 v160, v220, v221
  v_mul_f32 v222, v222, v86
  v_mul_f32 v223, v223, v86
  v_cvt_pk_bf16_f32 v161, v222, v223
  v_mul_f32 v224, v224, v86
  v_mul_f32 v225, v225, v86
  v_cvt_pk_bf16_f32 v162, v224, v225
  v_mul_f32 v226, v226, v86
  v_mul_f32 v227, v227, v86
  v_cvt_pk_bf16_f32 v163, v226, v227
  v_mul_f32 v228, v228, v86
  v_mul_f32 v229, v229, v86
  v_cvt_pk_bf16_f32 v164, v228, v229
  v_mul_f32 v230, v230, v86
  v_mul_f32 v231, v231, v86
  v_cvt_pk_bf16_f32 v165, v230, v231
  v_mul_f32 v232, v232, v86
  v_mul_f32 v233, v233, v86
  v_cvt_pk_bf16_f32 v166, v232, v233
  v_mul_f32 v234, v234, v86
  v_mul_f32 v235, v235, v86
  v_cvt_pk_bf16_f32 v167, v234, v235
  v_mul_f32 v236, v236, v86
  v_mul_f32 v237, v237, v86
  v_cvt_pk_bf16_f32 v168, v236, v237
  v_mul_f32 v238, v238, v86
  v_mul_f32 v239, v239, v86
  v_cvt_pk_bf16_f32 v169, v238, v239
  v_mul_f32 v240, v240, v86
  v_mul_f32 v241, v241, v86
  v_cvt_pk_bf16_f32 v170, v240, v241
  v_mul_f32 v242, v242, v86
  v_mul_f32 v243, v243, v86
  v_cvt_pk_bf16_f32 v171, v242, v243
  ds_read_b64_tr_b16 v[60:61], v10 offset:0
  ds_read_b64_tr_b16 v[62:63], v10 offset:256
  ds_read_b64_tr_b16 v[64:65], v10 offset:512
  ds_read_b64_tr_b16 v[66:67], v10 offset:768
  s_waitcnt lgkmcnt(2)
  v_mfma_f32_32x32x16_bf16 v[68:83], v[60:63], v[100:103], 0
  ds_read_b64_tr_b16 v[60:61], v10 offset:1024
  ds_read_b64_tr_b16 v[62:63], v10 offset:1280
  s_waitcnt lgkmcnt(2)
  v_mfma_f32_32x32x16_bf16 v[68:83], v[64:67], v[104:107], v[68:83]
  ds_read_b64_tr_b16 v[64:65], v10 offset:1536
  ds_read_b64_tr_b16 v[66:67], v10 offset:1792
  s_waitcnt lgkmcnt(2)
  v_mfma_f32_32x32x16_bf16 v[68:83], v[60:63], v[108:111], v[68:83]
  ds_read_b64_tr_b16 v[60:61], v10 offset:2048
  ds_read_b64_tr_b16 v[62:63], v10 offset:2304
  s_waitcnt lgkmcnt(2)
  v_mfma_f32_32x32x16_bf16 v[68:83], v[64:67], v[112:115], v[68:83]
  ds_read_b64_tr_b16 v[64:65], v10 offset:2560
  ds_read_b64_tr_b16 v[66:67], v10 offset:2816
  s_waitcnt lgkmcnt(2)
  v_mfma_f32_32x32x16_bf16 v[68:83], v[60:63], v[116:119], v[68:83]
  ds_read_b64_tr_b16 v[60:61], v10 offset:3072
  ds_read_b64_tr_b16 v[62:63], v10 offset:3328
  s_waitcnt lgkmcnt(2)
  v_mfma_f32_32x32x16_bf16 v[68:83], v[64:67], v[120:123], v[68:83]
  ds_read_b64_tr_b16 v[64:65], v10 offset:3584
  ds_read_b64_tr_b16 v[66:67], v10 offset:3840
  s_waitcnt lgkmcnt(2)
  v_mfma_f32_32x32x16_bf16 v[68:83], v[60:63], v[124:127], v[68:83]
  ds_read_b64_tr_b16 v[60:61], v10 offset:4096
  ds_read_b64_tr_b16 v[62:63], v10 offset:4352
  s_waitcnt lgkmcnt(2)
  v_mfma_f32_32x32x16_bf16 v[68:83], v[64:67], v[128:131], v[68:83]
  ds_read_b64_tr_b16 v[64:65], v10 offset:4608
  ds_read_b64_tr_b16 v[66:67], v10 offset:4864
  s_waitcnt lgkmcnt(2)
  v_mfma_f32_32x32x16_bf16 v[68:83], v[60:63], v[132:135], v[68:83]
  ds_read_b64_tr_b16 v[60:61], v10 offset:5120
  ds_read_b64_tr_b16 v[62:63], v10 offset:5376
  s_waitcnt lgkmcnt(2)
  v_mfma_f32_32x32x16_bf16 v[68:83], v[64:67], v[136:139], v[68:83]
  ds_read_b64_tr_b16 v[64:65], v10 offset:5632
  ds_read_b64_tr_b16 v[66:67], v10 offset:5888
  s_waitcnt lgkmcnt(2)
  v_mfma_f32_32x32x16_bf16 v[68:83], v[60:63], v[140:143], v[68:83]
  ds_read_b64_tr_b16 v[60:61], v10 offset:6144
  ds_read_b64_tr_b16 v[62:63], v10 offset:6400
  s_waitcnt lgkmcnt(2)
  v_mfma_f32_32x32x16_bf16 v[68:83], v[64:67], v[144:147], v[68:83]
  ds_read_b64_tr_b16 v[64:65], v10 offset:6656
  ds_read_b64_tr_b16 v[66:67], v10 offset:6912
  s_waitcnt lgkmcnt(2)
  v_mfma_f32_32x32x16_bf16 v[68:83], v[60:63], v[148:151], v[68:83]
  ds_read_b64_tr_b16 v[60:61], v10 offset:7168
  ds_read_b64_tr_b16 v[62:63], v10 offset:7424
  s_waitcnt lgkmcnt(2)
  v_mfma_f32_32x32x16_bf16 v[68:83], v[64:67], v[152:155], v[68:83]
  ds_read_b64_tr_b16 v[64:65], v10 offset:7680
  ds_read_b64_tr_b16 v[66:67], v10 offset:7936
  s_waitcnt lgkmcnt(2)
  v_mfma_f32_32x32x16_bf16 v[68:83], v[60:63], v[156:159], v[68:83]
  ds_read_b64_tr_b16 v[60:61], v10 offset:8192
  ds_read_b64_tr_b16 v[62:63], v10 offset:8448
  s_waitcnt lgkmcnt(2)
  v_mfma_f32_32x32x16_bf16 v[68:83], v[64:67], v[160:163], v[68:83]
  ds_read_b64_tr_b16 v[64:65], v10 offset:8704
  ds_read_b64_tr_b16 v[66:67], v10 offset:8960
  s_waitcnt lgkmcnt(2)
  v_mfma_f32_32x32x16_bf16 v[68:83], v[60:63], v[164:167], v[68:83]
  s_waitcnt lgkmcnt(0)
  v_mfma_f32_32x32x16_bf16 v[68:83], v[64:67], v[168:171], v[68:83]
  s_nop 15
  s_nop 3
  v_add_u32 v8, s25, v6
  v_lshlrev_b32 v8, 10, v8
  v_lshl_add_u32 v8, v7, 3, v8
  s_lshl_b32 s26, s14, 5
  v_add_u32 v8, s26, v8
  s_add_u32 s20, s12, 16777216
  s_addc_u32 s21, s13, 0
  v_cvt_pk_bf16_f32 v84, v68, v69
  v_cvt_pk_bf16_f32 v85, v70, v71
  global_store_dwordx2 v8, v[84:85], s[20:21] offset:0
  s_nop 0
  v_cvt_pk_bf16_f32 v84, v72, v73
  v_cvt_pk_bf16_f32 v85, v74, v75
  global_store_dwordx2 v8, v[84:85], s[20:21] offset:16
  s_nop 0
k2_end:
  s_endpgm
.globl recurrent_scan__sliding_block__glu_gated_geglu__prompt_kernel
.p2align 8
.type recurrent_scan__sliding_block__glu_gated_geglu__prompt_kernel,@function
recurrent_scan__sliding_block__glu_gated_geglu__prompt_kernel:
  s_cmp_ge_u32 s2, 256
  s_cbranch_scc1 k3_end
  s_load_dwordx2 s[4:5], s[0:1], 0
  s_load_dwordx2 s[6:7], s[0:1], 16
  s_load_dwordx2 s[8:9], s[0:1], 48
  s_load_dwordx2 s[10:11], s[0:1], 56
  s_load_dwordx2 s[12:13], s[0:1], 72
  s_and_b32 s14, s2, 7
  s_lshl_b32 s14, s14, 2
  s_lshr_b32 s15, s2, 6
  s_add_u32 s14, s14, s15
  s_lshr_b32 s15, s2, 3
  s_and_b32 s15, s15, 7
  v_and_b32 v1, 63, v0
  v_lshrrev_b32 v2, 6, v0
  s_nop 0
  v_readfirstlane_b32 s16, v2
  s_and_b32 s20, s16, 1
  s_lshr_b32 s21, s16, 1
  v_lshrrev_b32 v3, 5, v1
  v_and_b32 v4, 31, v1
  s_lshl_b32 s17, s14, 6
  s_lshl_b32 s18, s16, 4
  s_add_u32 s17, s17, s18
  v_lshrrev_b32 v5, 3, v1
  v_add_u32 v5, s17, v5
  v_lshrrev_b32 v8, 4, v1
  v_and_b32 v9, 7, v1
  v_add_u32 v6, 0, v8
  v_xor_b32 v6, v9, v6
  v_lshlrev_b32 v6, 4, v6
  v_add_u32 v7, 0, v5
  v_lshl_add_u32 v160, v7, 10, v6
  s_movk_i32 s24, 3584
  v_mul_lo_u32 v7, v7, s24
  v_add_u32 v162, v7, v6
  v_add_u32 v6, 4, v8
  v_xor_b32 v6, v9, v6
  v_lshlrev_b32 v6, 4, v6
  v_add_u32 v7, 8, v5
  v_lshl_add_u32 v161, v7, 10, v6
  s_movk_i32 s24, 3584
  v_mul_lo_u32 v7, v7, s24
  v_add_u32 v163, v7, v6
  v_lshrrev_b32 v6, 3, v1
  v_lshrrev_b32 v7, 1, v6
  v_and_b32 v7, 1, v7
  v_lshlrev_b32 v7, 2, v7
  v_and_b32 v8, 7, v1
  v_xor_b32 v7, v7, v8
  s_lshl_b32 s24, s16, 4
  v_add_u32 v6, s24, v6
  v_lshlrev_b32 v6, 10, v6
  v_lshl_add_u32 v6, v7, 4, v6
  s_lshl_b32 s24, s15, 7
  v_add_u32 v164, s24, v6
  s_lshl_b32 s24, s20, 5
  v_add_u32 v6, s24, v4
  v_lshlrev_b32 v7, 7, v6
  v_lshrrev_b32 v8, 1, v1
  v_and_b32 v8, 7, v8
  v_and_b32 v84, 1, v8
  v_xor_b32 v9, v3, v84
  v_lshrrev_b32 v8, 1, v8
  v_xor_b32 v84, 0, v8
  v_lshl_or_b32 v84, v84, 1, v9
  v_lshl_add_u32 v150, v84, 4, v7
  v_add_u32 v154, 0x10000, v150
  v_xor_b32 v84, 1, v8
  v_lshl_or_b32 v84, v84, 1, v9
  v_lshl_add_u32 v151, v84, 4, v7
  v_add_u32 v155, 0x10000, v151
  v_xor_b32 v84, 2, v8
  v_lshl_or_b32 v84, v84, 1, v9
  v_lshl_add_u32 v152, v84, 4, v7
  v_add_u32 v156, 0x10000, v152
  v_xor_b32 v84, 3, v8
  v_lshl_or_b32 v84, v84, 1, v9
  v_lshl_add_u32 v153, v84, 4, v7
  v_add_u32 v157, 0x10000, v153
  v_lshrrev_b32 v7, 4, v1
  v_and_b32 v8, 15, v1
  v_lshrrev_b32 v9, 1, v7
  v_lshlrev_b32 v9, 3, v9
  v_lshrrev_b32 v84, 2, v8
  v_add_u32 v9, v9, v84
  v_lshlrev_b32 v9, 7, v9
  v_and_b32 v84, 1, v7
  v_lshl_add_u32 v9, v84, 5, v9
  v_and_b32 v84, 3, v8
  v_lshl_add_u32 v9, v84, 3, v9
  v_lshrrev_b32 v84, 3, v8
  v_xor_b32 v84, s21, v84
  v_lshl_add_u32 v9, v84, 6, v9
  v_add_u32 v158, 0x2000, v9
  v_add_u32 v159, 0x10000, v158
  s_waitcnt lgkmcnt(0)
  s_lshl_b32 s22, s16, 11
  s_lshl_b32 s23, s16, 11
  s_add_u32 s23, s23, 8192
  v_lshlrev_b32 v165, 4, v1
  v_add_u32 v166, s22, v165
  v_add_u32 v165, s23, v165
  v_mov_b32 v100, 0
  v_mov_b32 v101, 0
  v_mov_b32 v102, 0
  v_mov_b32 v103, 0
  v_mov_b32 v104, 0
  v_mov_b32 v105, 0
  v_mov_b32 v106, 0
  v_mov_b32 v107, 0
  v_mov_b32 v108, 0
  v_mov_b32 v109, 0
  v_mov_b32 v110, 0
  v_mov_b32 v111, 0
  v_mov_b32 v112, 0
  v_mov_b32 v113, 0
  v_mov_b32 v114, 0
  v_mov_b32 v115, 0
  v_mov_b32 v116, 0
  v_mov_b32 v117, 0
  v_mov_b32 v118, 0
  v_mov_b32 v119, 0
  v_mov_b32 v120, 0
  v_mov_b32 v121, 0
  v_mov_b32 v122, 0
  v_mov_b32 v123, 0
  v_mov_b32 v124, 0
  v_mov_b32 v125, 0
  v_mov_b32 v126, 0
  v_mov_b32 v127, 0
  v_mov_b32 v128, 0
  v_mov_b32 v129, 0
  v_mov_b32 v130, 0
  v_mov_b32 v131, 0
  s_add_u32 s30, s12, 16777216
  s_addc_u32 s31, s13, 0
  global_load_dwordx4 v[170:173], v160, s[30:31]
  global_load_dwordx4 v[174:177], v161, s[30:31]
  s_add_u32 s32, s6, 0
  s_addc_u32 s33, s7, 0
  global_load_dwordx4 v[178:181], v164, s[32:33]
  s_add_u32 s32, s6, 8192
  s_addc_u32 s33, s7, 0
  global_load_dwordx4 v[182:185], v164, s[32:33]
  s_add_u32 s30, s12, 16777344
  s_addc_u32 s31, s13, 0
  global_load_dwordx4 v[186:189], v160, s[30:31]
  global_load_dwordx4 v[190:193], v161, s[30:31]
  s_add_u32 s32, s6, 65536
  s_addc_u32 s33, s7, 0
  global_load_dwordx4 v[194:197], v164, s[32:33]
  s_add_u32 s32, s6, 73728
  s_addc_u32 s33, s7, 0
  global_load_dwordx4 v[198:201], v164, s[32:33]
  s_add_u32 s30, s12, 16777472
  s_addc_u32 s31, s13, 0
  global_load_dwordx4 v[202:205], v160, s[30:31]
  global_load_dwordx4 v[206:209], v161, s[30:31]
  s_add_u32 s32, s6, 131072
  s_addc_u32 s33, s7, 0
  global_load_dwordx4 v[210:213], v164, s[32:33]
  s_add_u32 s32, s6, 139264
  s_addc_u32 s33, s7, 0
  global_load_dwordx4 v[214:217], v164, s[32:33]
  s_add_u32 s30, s12, 16777600
  s_addc_u32 s31, s13, 0
  global_load_dwordx4 v[218:221], v160, s[30:31]
  global_load_dwordx4 v[222:225], v161, s[30:31]
  s_add_u32 s32, s6, 196608
  s_addc_u32 s33, s7, 0
  global_load_dwordx4 v[226:229], v164, s[32:33]
  s_add_u32 s32, s6, 204800
  s_addc_u32 s33, s7, 0
  global_load_dwordx4 v[230:233], v164, s[32:33]
  s_add_u32 s30, s12, 16777728
  s_addc_u32 s31, s13, 0
  global_load_dwordx4 v[234:237], v160, s[30:31]
  global_load_dwordx4 v[238:241], v161, s[30:31]
  s_add_u32 s32, s6, 262144
  s_addc_u32 s33, s7, 0
  global_load_dwordx4 v[242:245], v164, s[32:33]
  s_add_u32 s32, s6, 270336
  s_addc_u32 s33, s7, 0
  global_load_dwordx4 v[246:249], v164, s[32:33]
  s_waitcnt vmcnt(12)
  ds_write_b128 v166, v[170:173] offset:0
  ds_write_b128 v166, v[174:177] offset:1024
  ds_write_b128 v165, v[178:181] offset:0
  ds_write_b128 v165, v[182:185] offset:1024
  ds_write_b128 v166, v[186:189] offset:16384
  ds_write_b128 v166, v[190:193] offset:17408
  ds_write_b128 v165, v[194:197] offset:16384
  ds_write_b128 v165, v[198:201] offset:17408
  s_waitcnt lgkmcnt(0)
  s_barrier
  s_add_u32 s30, s12, 16777856
  s_addc_u32 s31, s13, 0
  global_load_dwordx4 v[170:173], v160, s[30:31]
  global_load_dwordx4 v[174:177], v161, s[30:31]
  s_add_u32 s32, s6, 327680
  s_addc_u32 s33, s7, 0
  global_load_dwordx4 v[178:181], v164, s[32:33]
  s_add_u32 s32, s6, 335872
  s_addc_u32 s33, s7, 0
  global_load_dwordx4 v[182:185], v164, s[32:33]
  s_add_u32 s30, s12, 16777984
  s_addc_u32 s31, s13, 0
  global_load_dwordx4 v[186:189], v160, s[30:31]
  global_load_dwordx4 v[190:193], v161, s[30:31]
  s_add_u32 s32, s6, 393216
  s_addc_u32 s33, s7, 0
  global_load_dwordx4 v[194:197], v164, s[32:33]
  s_add_u32 s32, s6, 401408
  s_addc_u32 s33, s7, 0
  global_load_dwordx4 v[198:201], v164, s[32:33]
  ds_read_b128 v[20:23], v150 offset:0
  ds_read_b64_tr_b16 v[52:53], v158 offset:0
  ds_read_b64_tr_b16 v[54:55], v158 offset:512
  ds_read_b128 v[24:27], v151 offset:0
  ds_read_b64_tr_b16 v[56:57], v158 offset:2048
  ds_read_b64_tr_b16 v[58:59], v158 offset:2560
  ds_read_b128 v[28:31], v152 offset:0
  ds_read_b64_tr_b16 v[60:61], v158 offset:4096
  ds_read_b64_tr_b16 v[62:63], v158 offset:4608
  ds_read_b128 v[32:35], v153 offset:0
  ds_read_b64_tr_b16 v[64:65], v158 offset:6144
  ds_read_b64_tr_b16 v[66:67], v158 offset:6656
  ds_read_b128 v[36:39], v150 offset:16384
  ds_read_b64_tr_b16 v[68:69], v158 offset:16384
  ds_read_b64_tr_b16 v[70:71], v158 offset:16896
  s_waitcnt lgkmcnt(12)
  v_mfma_f32_32x32x16_bf16 v[100:115], v[52:55], v[20:23], v[100:115]
  ds_read_b128 v[40:43], v151 offset:16384
  ds_read_b64_tr_b16 v[72:73], v158 offset:18432
  ds_read_b64_tr_b16 v[74:75], v158 offset:18944
  s_waitcnt lgkmcnt(12)
  v_mfma_f32_32x32x16_bf16 v[100:115], v[56:59], v[24:27], v[100:115]
  ds_read_b128 v[44:47], v152 offset:16384
  ds_read_b64_tr_b16 v[76:77], v158 offset:20480
  ds_read_b64_tr_b16 v[78:79], v158 offset:20992
  s_waitcnt lgkmcnt(12)
  v_mfma_f32_32x32x16_bf16 v[100:115], v[60:63], v[28:31], v[100:115]
  ds_read_b128 v[48:51], v153 offset:16384
  ds_read_b64_tr_b16 v[80:81], v158 offset:22528
  ds_read_b64_tr_b16 v[82:83], v158 offset:23040
  s_waitcnt lgkmcnt(12)
  v_mfma_f32_32x32x16_bf16 v[100:115], v[64:67], v[32:35], v[100:115]
  s_waitcnt lgkmcnt(9)
  v_mfma_f32_32x32x16_bf16 v[100:115], v[68:71], v[36:39], v[100:115]
  s_waitcnt vmcnt(12)
  ds_write_b128 v166, v[202:205] offset:32768
  ds_write_b128 v166, v[206:209] offset:33792
  ds_write_b128 v165, v[210:213] offset:32768
  ds_write_b128 v165, v[214:217] offset:33792
  ds_write_b128 v166, v[218:221] offset:49152
  ds_write_b128 v166, v[222:225] offset:50176
  ds_write_b128 v165, v[226:229] offset:49152
  ds_write_b128 v165, v[230:233] offset:50176
  s_waitcnt lgkmcnt(14)
  v_mfma_f32_32x32x16_bf16 v[100:115], v[72:75], v[40:43], v[100:115]
  s_waitcnt lgkmcnt(0)
  s_barrier
  ds_read_b128 v[20:23], v150 offset:32768
  ds_read_b64_tr_b16 v[52:53], v158 offset:32768
  ds_read_b64_tr_b16 v[54:55], v158 offset:33280
  ds_read_b128 v[24:27], v151 offset:32768
  ds_read_b64_tr_b16 v[56:57], v158 offset:34816
  ds_read_b64_tr_b16 v[58:59], v158 offset:35328
  v_mfma_f32_32x32x16_bf16 v[100:115], v[76:79], v[44:47], v[100:115]
  s_add_u32 s30, s12, 16778112
  s_addc_u32 s31, s13, 0
  global_load_dwordx4 v[202:205], v160, s[30:31]
  global_load_dwordx4 v[206:209], v161, s[30:31]
  s_add_u32 s32, s6, 458752
  s_addc_u32 s33, s7, 0
  global_load_dwordx4 v[210:213], v164, s[32:33]
  s_add_u32 s32, s6, 466944
  s_addc_u32 s33, s7, 0
  global_load_dwordx4 v[214:217], v164, s[32:33]
  s_add_u32 s30, s12, 8388608
  s_addc_u32 s31, s13, 0
  global_load_dwordx4 v[218:221], v162, s[30:31]
  global_load_dwordx4 v[222:225], v163, s[30:31]
  s_add_u32 s32, s8, 0
  s_addc_u32 s33, s9, 0
  global_load_dwordx4 v[226:229], v164, s[32:33]
  s_add_u32 s32, s8, 8192
  s_addc_u32 s33, s9, 0
  global_load_dwordx4 v[230:233], v164, s[32:33]
  ds_read_b128 v[28:31], v152 offset:32768
  ds_read_b64_tr_b16 v[60:61], v158 offset:36864
  ds_read_b64_tr_b16 v[62:63], v158 offset:37376
  ds_read_b128 v[32:35], v153 offset:32768
  ds_read_b64_tr_b16 v[64:65], v158 offset:38912
  ds_read_b64_tr_b16 v[66:67], v158 offset:39424
  v_mfma_f32_32x32x16_bf16 v[100:115], v[80:83], v[48:51], v[100:115]
  ds_read_b128 v[36:39], v150 offset:49152
  ds_read_b64_tr_b16 v[68:69], v158 offset:49152
  ds_read_b64_tr_b16 v[70:71], v158 offset:49664
  s_waitcnt lgkmcnt(12)
  v_mfma_f32_32x32x16_bf16 v[100:115], v[52:55], v[20:23], v[100:115]
  ds_read_b128 v[40:43], v151 offset:49152
  ds_read_b64_tr_b16 v[72:73], v158 offset:51200
  ds_read_b64_tr_b16 v[74:75], v158 offset:51712
  s_waitcnt lgkmcnt(12)
  v_mfma_f32_32x32x16_bf16 v[100:115], v[56:59], v[24:27], v[100:115]
  ds_read_b128 v[44:47], v152 offset:49152
  ds_read_b64_tr_b16 v[76:77], v158 offset:53248
  ds_read_b64_tr_b16 v[78:79], v158 offset:53760
  s_waitcnt lgkmcnt(12)
  v_mfma_f32_32x32x16_bf16 v[100:115], v[60:63], v[28:31], v[100:115]
  ds_read_b128 v[48:51], v153 offset:49152
  ds_read_b64_tr_b16 v[80:81], v158 offset:55296
  ds_read_b64_tr_b16 v[82:83], v158 offset:55808
  s_waitcnt lgkmcnt(12)
  v_mfma_f32_32x32x16_bf16 v[100:115], v[64:67], v[32:35], v[100:115]
  s_waitcnt lgkmcnt(9)
  v_mfma_f32_32x32x16_bf16 v[100:115], v[68:71], v[36:39], v[100:115]
  s_waitcnt vmcnt(12)
  ds_write_b128 v166, v[234:237] offset:0
  ds_write_b128 v166, v[238:241] offset:1024
  ds_write_b128 v165, v[242:245] offset:0
  ds_write_b128 v165, v[246:249] offset:1024
  ds_write_b128 v166, v[170:173] offset:16384
  ds_write_b128 v166, v[174:177] offset:17408
  ds_write_b128 v165, v[178:181] offset:16384
  ds_write_b128 v165, v[182:185] offset:17408
  s_waitcnt lgkmcnt(14)
  v_mfma_f32_32x32x16_bf16 v[100:115], v[72:75], v[40:43], v[100:115]
  s_waitcnt lgkmcnt(0)
  s_barrier
  ds_read_b128 v[20:23], v150 offset:0
  ds_read_b64_tr_b16 v[52:53], v158 offset:0
  ds_read_b64_tr_b16 v[54:55], v158 offset:512
  ds_read_b128 v[24:27], v151 offset:0
  ds_read_b64_tr_b16 v[56:57], v158 offset:2048
  ds_read_b64_tr_b16 v[58:59], v158 offset:2560
  v_mfma_f32_32x32x16_bf16 v[100:115], v[76:79], v[44:47], v[100:115]
  s_add_u32 s30, s12, 8388736
  s_addc_u32 s31, s13, 0
  global_load_dwordx4 v[234:237], v162, s[30:31]
  global_load_dwordx4 v[238:241], v163, s[30:31]
  s_add_u32 s32, s8, 65536
  s_addc_u32 s33, s9, 0
  global_load_dwordx4 v[242:245], v164, s[32:33]
  s_add_u32 s32, s8, 73728
  s_addc_u32 s33, s9, 0
  global_load_dwordx4 v[246:249], v164, s[32:33]
  s_add_u32 s30, s12, 8388864
  s_addc_u32 s31, s13, 0
  global_load_dwordx4 v[170:173], v162, s[30:31]
  global_load_dwordx4 v[174:177], v163, s[30:31]
  s_add_u32 s32, s8, 131072
  s_addc_u32 s33, s9, 0
  global_load_dwordx4 v[178:181], v164, s[32:33]
  s_add_u32 s32, s8, 139264
  s_addc_u32 s33, s9, 0
  global_load_dwordx4 v[182:185], v164, s[32:33]
  ds_read_b128 v[28:31], v152 offset:0
  ds_read_b64_tr_b16 v[60:61], v158 offset:4096
  ds_read_b64_tr_b16 v[62:63], v158 offset:4608
  ds_read_b128 v[32:35], v153 offset:0
  ds_read_b64_tr_b16 v[64:65], v158 offset:6144
  ds_read_b64_tr_b16 v[66:67], v158 offset:6656
  v_mfma_f32_32x32x16_bf16 v[100:115], v[80:83], v[48:51], v[100:115]
  ds_read_b128 v[36:39], v150 offset:16384
  ds_read_b64_tr_b16 v[68:69], v158 offset:16384
  ds_read_b64_tr_b16 v[70:71], v158 offset:16896
  s_waitcnt lgkmcnt(12)
  v_mfma_f32_32x32x16_bf16 v[100:115], v[52:55], v[20:23], v[100:115]
  ds_read_b128 v[40:43], v151 offset:16384
  ds_read_b64_tr_b16 v[72:73], v158 offset:18432
  ds_read_b64_tr_b16 v[74:75], v158 offset:18944
  s_waitcnt lgkmcnt(12)
  v_mfma_f32_32x32x16_bf16 v[100:115], v[56:59], v[24:27], v[100:115]
  ds_read_b128 v[44:47], v152 offset:16384
  ds_read_b64_tr_b16 v[76:77], v158 offset:20480
  ds_read_b64_tr_b16 v[78:79], v158 offset:20992
  s_waitcnt lgkmcnt(12)
  v_mfma_f32_32x32x16_bf16 v[100:115], v[60:63], v[28:31], v[100:115]
  ds_read_b128 v[48:51], v153 offset:16384
  ds_read_b64_tr_b16 v[80:81], v158 offset:22528
  ds_read_b64_tr_b16 v[82:83], v158 offset:23040
  s_waitcnt lgkmcnt(12)
  v_mfma_f32_32x32x16_bf16 v[100:115], v[64:67], v[32:35], v[100:115]
  s_waitcnt lgkmcnt(9)
  v_mfma_f32_32x32x16_bf16 v[100:115], v[68:71], v[36:39], v[100:115]
  s_waitcnt vmcnt(12)
  ds_write_b128 v166, v[186:189] offset:32768
  ds_write_b128 v166, v[190:193] offset:33792
  ds_write_b128 v165, v[194:197] offset:32768
  ds_write_b128 v165, v[198:201] offset:33792
  ds_write_b128 v166, v[202:205] offset:49152
  ds_write_b128 v166, v[206:209] offset:50176
  ds_write_b128 v165, v[210:213] offset:49152
  ds_write_b128 v165, v[214:217] offset:50176
  s_waitcnt lgkmcnt(14)
  v_mfma_f32_32x32x16_bf16 v[100:115], v[72:75], v[40:43], v[100:115]
  s_waitcnt lgkmcnt(0)
  s_barrier
  ds_read_b128 v[20:23], v150 offset:32768
  ds_read_b64_tr_b16 v[52:53], v158 offset:32768
  ds_read_b64_tr_b16 v[54:55], v158 offset:33280
  ds_read_b128 v[24:27], v151 offset:32768
  ds_read_b64_tr_b16 v[56:57], v158 offset:34816
  ds_read_b64_tr_b16 v[58:59], v158 offset:35328
  v_mfma_f32_32x32x16_bf16 v[100:115], v[76:79], v[44:47], v[100:115]
  s_add_u32 s30, s12, 8388992
  s_addc_u32 s31, s13, 0
  global_load_dwordx4 v[186:189], v162, s[30:31]
  global_load_dwordx4 v[190:193], v163, s[30:31]
  s_add_u32 s32, s8, 196608
  s_addc_u32 s33, s9, 0
  global_load_dwordx4 v[194:197], v164, s[32:33]
  s_add_u32 s32, s8, 204800
  s_addc_u32 s33, s9, 0
  global_load_dwordx4 v[198:201], v164, s[32:33]
  s_add_u32 s30, s12, 8389120
  s_addc_u32 s31, s13, 0
  global_load_dwordx4 v[202:205], v162, s[30:31]
  global_load_dwordx4 v[206:209], v163, s[30:31]
  s_add_u32 s32, s8, 262144
  s_addc_u32 s33, s9, 0
  global_load_dwordx4 v[210:213], v164, s[32:33]
  s_add_u32 s32, s8, 270336
  s_addc_u32 s33, s9, 0
  global_load_dwordx4 v[214:217], v164, s[32:33]
  ds_read_b128 v[28:31], v152 offset:32768
  ds_read_b64_tr_b16 v[60:61], v158 offset:36864
  ds_read_b64_tr_b16 v[62:63], v158 offset:37376
  ds_read_b128 v[32:35], v153 offset:32768
  ds_read_b64_tr_b16 v[64:65], v158 offset:38912
  ds_read_b64_tr_b16 v[66:67], v158 offset:39424
  v_mfma_f32_32x32x16_bf16 v[100:115], v[80:83], v[48:51], v[100:115]
  ds_read_b128 v[36:39], v150 offset:49152
  ds_read_b64_tr_b16 v[68:69], v158 offset:49152
  ds_read_b64_tr_b16 v[70:71], v158 offset:49664
  s_waitcnt lgkmcnt(12)
  v_mfma_f32_32x32x16_bf16 v[100:115], v[52:55], v[20:23], v[100:115]
  ds_read_b128 v[40:43], v151 offset:49152
  ds_read_b64_tr_b16 v[72:73], v158 offset:51200
  ds_read_b64_tr_b16 v[74:75], v158 offset:51712
  s_waitcnt lgkmcnt(12)
  v_mfma_f32_32x32x16_bf16 v[100:115], v[56:59], v[24:27], v[100:115]
  ds_read_b128 v[44:47], v152 offset:49152
  ds_read_b64_tr_b16 v[76:77], v158 offset:53248
  ds_read_b64_tr_b16 v[78:79], v158 offset:53760
  s_waitcnt lgkmcnt(12)
  v_mfma_f32_32x32x16_bf16 v[100:115], v[60:63], v[28:31], v[100:115]
  ds_read_b128 v[48:51], v153 offset:49152
  ds_read_b64_tr_b16 v[80:81], v158 offset:55296
  ds_read_b64_tr_b16 v[82:83], v158 offset:55808
  s_waitcnt lgkmcnt(12)
  v_mfma_f32_32x32x16_bf16 v[100:115], v[64:67], v[32:35], v[100:115]
  s_waitcnt lgkmcnt(9)
  v_mfma_f32_32x32x16_bf16 v[100:115], v[68:71], v[36:39], v[100:115]
  s_waitcnt vmcnt(12)
  ds_write_b128 v166, v[218:221] offset:0
  ds_write_b128 v166, v[222:225] offset:1024
  ds_write_b128 v165, v[226:229] offset:0
  ds_write_b128 v165, v[230:233] offset:1024
  ds_write_b128 v166, v[234:237] offset:16384
  ds_write_b128 v166, v[238:241] offset:17408
  ds_write_b128 v165, v[242:245] offset:16384
  ds_write_b128 v165, v[246:249] offset:17408
  s_waitcnt lgkmcnt(14)
  v_mfma_f32_32x32x16_bf16 v[100:115], v[72:75], v[40:43], v[100:115]
  s_waitcnt lgkmcnt(0)
  s_barrier
  ds_read_b128 v[20:23], v150 offset:0
  ds_read_b64_tr_b16 v[52:53], v158 offset:0
  ds_read_b64_tr_b16 v[54:55], v158 offset:512
  ds_read_b128 v[24:27], v151 offset:0
  ds_read_b64_tr_b16 v[56:57], v158 offset:2048
  ds_read_b64_tr_b16 v[58:59], v158 offset:2560
  v_mfma_f32_32x32x16_bf16 v[100:115], v[76:79], v[44:47], v[100:115]
  s_add_u32 s30, s12, 8389248
  s_addc_u32 s31, s13, 0
  global_load_dwordx4 v[218:221], v162, s[30:31]
  global_load_dwordx4 v[222:225], v163, s[30:31]
  s_add_u32 s32, s8, 327680
  s_addc_u32 s33, s9, 0
  global_load_dwordx4 v[226:229], v164, s[32:33]
  s_add_u32 s32, s8, 335872
  s_addc_u32 s33, s9, 0
  global_load_dwordx4 v[230:233], v164, s[32:33]
  s_add_u32 s30, s12, 8389376
  s_addc_u32 s31, s13, 0
  global_load_dwordx4 v[234:237], v162, s[30:31]
  global_load_dwordx4 v[238:241], v163, s[30:31]
  s_add_u32 s32, s8, 393216
  s_addc_u32 s33, s9, 0
  global_load_dwordx4 v[242:245], v164, s[32:33]
  s_add_u32 s32, s8, 401408
  s_addc_u32 s33, s9, 0
  global_load_dwordx4 v[246:249], v164, s[32:33]
  ds_read_b128 v[28:31], v152 offset:0
  ds_read_b64_tr_b16 v[60:61], v158 offset:4096
  ds_read_b64_tr_b16 v[62:63], v158 offset:4608
  ds_read_b128 v[32:35], v153 offset:0
  ds_read_b64_tr_b16 v[64:65], v158 offset:6144
  ds_read_b64_tr_b16 v[66:67], v158 offset:6656
  v_mfma_f32_32x32x16_bf16 v[100:115], v[80:83], v[48:51], v[100:115]
  ds_read_b128 v[36:39], v150 offset:16384
  ds_read_b64_tr_b16 v[68:69], v158 offset:16384
  ds_read_b64_tr_b16 v[70:71], v158 offset:16896
  s_waitcnt lgkmcnt(12)
  v_mfma_f32_32x32x16_bf16 v[116:131], v[52:55], v[20:23], v[116:131]
  ds_read_b128 v[40:43], v151 offset:16384
  ds_read_b64_tr_b16 v[72:73], v158 offset:18432
  ds_read_b64_tr_b16 v[74:75], v158 offset:18944
  s_waitcnt lgkmcnt(12)
  v_mfma_f32_32x32x16_bf16 v[116:131], v[56:59], v[24:27], v[116:131]
  ds_read_b128 v[44:47], v152 offset:16384
  ds_read_b64_tr_b16 v[76:77], v158 offset:20480
  ds_read_b64_tr_b16 v[78:79], v158 offset:20992
  s_waitcnt lgkmcnt(12)
  v_mfma_f32_32x32x16_bf16 v[116:131], v[60:63], v[28:31], v[116:131]
  ds_read_b128 v[48:51], v153 offset:16384
  ds_read_b64_tr_b16 v[80:81], v158 offset:22528
  ds_read_b64_tr_b16 v[82:83], v158 offset:23040
  s_waitcnt lgkmcnt(12)
  v_mfma_f32_32x32x16_bf16 v[116:131], v[64:67], v[32:35], v[116:131]
  s_waitcnt lgkmcnt(9)
  v_mfma_f32_32x32x16_bf16 v[116:131], v[68:71], v[36:39], v[116:131]
  s_waitcnt vmcnt(12)
  ds_write_b128 v166, v[170:173] offset:32768
  ds_write_b128 v166, v[174:177] offset:33792
  ds_write_b128 v165, v[178:181] offset:32768
  ds_write_b128 v165, v[182:185] offset:33792
  ds_write_b128 v166, v[186:189] offset:49152
  ds_write_b128 v166, v[190:193] offset:50176
  ds_write_b128 v165, v[194:197] offset:49152
  ds_write_b128 v165, v[198:201] offset:50176
  s_waitcnt lgkmcnt(14)
  v_mfma_f32_32x32x16_bf16 v[116:131], v[72:75], v[40:43], v[116:131]
  s_waitcnt lgkmcnt(0)
  s_barrier
  ds_read_b128 v[20:23], v150 offset:32768
  ds_read_b64_tr_b16 v[52:53], v158 offset:32768
  ds_read_b64_tr_b16 v[54:55], v158 offset:33280
  ds_read_b128 v[24:27], v151 offset:32768
  ds_read_b64_tr_b16 v[56:57], v158 offset:34816
  ds_read_b64_tr_b16 v[58:59], v158 offset:35328
  v_mfma_f32_32x32x16_bf16 v[116:131], v[76:79], v[44:47], v[116:131]
  s_add_u32 s30, s12, 8389504
  s_addc_u32 s31, s13, 0
  global_load_dwordx4 v[170:173], v162, s[30:31]
  global_load_dwordx4 v[174:177], v163, s[30:31]
  s_add_u32 s32, s8, 458752
  s_addc_u32 s33, s9, 0
  global_load_dwordx4 v[178:181], v164, s[32:33]
  s_add_u32 s32, s8, 466944
  s_addc_u32 s33, s9, 0
  global_load_dwordx4 v[182:185], v164, s[32:33]
  s_add_u32 s30, s12, 8389632
  s_addc_u32 s31, s13, 0
  global_load_dwordx4 v[186:189], v162, s[30:31]
  global_load_dwordx4 v[190:193], v163, s[30:31]
  s_add_u32 s32, s8, 524288
  s_addc_u32 s33, s9, 0
  global_load_dwordx4 v[194:197], v164, s[32:33]
  s_add_u32 s32, s8, 532480
  s_addc_u32 s33, s9, 0
  global_load_dwordx4 v[198:201], v164, s[32:33]
  ds_read_b128 v[28:31], v152 offset:32768
  ds_read_b64_tr_b16 v[60:61], v158 offset:36864
  ds_read_b64_tr_b16 v[62:63], v158 offset:37376
  ds_read_b128 v[32:35], v153 offset:32768
  ds_read_b64_tr_b16 v[64:65], v158 offset:38912
  ds_read_b64_tr_b16 v[66:67], v158 offset:39424
  v_mfma_f32_32x32x16_bf16 v[116:131], v[80:83], v[48:51], v[116:131]
  ds_read_b128 v[36:39], v150 offset:49152
  ds_read_b64_tr_b16 v[68:69], v158 offset:49152
  ds_read_b64_tr_b16 v[70:71], v158 offset:49664
  s_waitcnt lgkmcnt(12)
  v_mfma_f32_32x32x16_bf16 v[116:131], v[52:55], v[20:23], v[116:131]
  ds_read_b128 v[40:43], v151 offset:49152
  ds_read_b64_tr_b16 v[72:73], v158 offset:51200
  ds_read_b64_tr_b16 v[74:75], v158 offset:51712
  s_waitcnt lgkmcnt(12)
  v_mfma_f32_32x32x16_bf16 v[116:131], v[56:59], v[24:27], v[116:131]
  ds_read_b128 v[44:47], v152 offset:49152
  ds_read_b64_tr_b16 v[76:77], v158 offset:53248
  ds_read_b64_tr_b16 v[78:79], v158 offset:53760
  s_waitcnt lgkmcnt(12)
  v_mfma_f32_32x32x16_bf16 v[116:131], v[60:63], v[28:31], v[116:131]
  ds_read_b128 v[48:51], v153 offset:49152
  ds_read_b64_tr_b16 v[80:81], v158 offset:55296
  ds_read_b64_tr_b16 v[82:83], v158 offset:55808
  s_waitcnt lgkmcnt(12)
  v_mfma_f32_32x32x16_bf16 v[116:131], v[64:67], v[32:35], v[116:131]
  s_waitcnt lgkmcnt(9)
  v_mfma_f32_32x32x16_bf16 v[116:131], v[68:71], v[36:39], v[116:131]
  s_waitcnt vmcnt(12)
  ds_write_b128 v166, v[202:205] offset:0
  ds_write_b128 v166, v[206:209] offset:1024
  ds_write_b128 v165, v[210:213] offset:0
  ds_write_b128 v165, v[214:217] offset:1024
  ds_write_b128 v166, v[218:221] offset:16384
  ds_write_b128 v166, v[222:225] offset:17408
  ds_write_b128 v165, v[226:229] offset:16384
  ds_write_b128 v165, v[230:233] offset:17408
  s_waitcnt lgkmcnt(14)
  v_mfma_f32_32x32x16_bf16 v[116:131], v[72:75], v[40:43], v[116:131]
  s_waitcnt lgkmcnt(0)
  s_barrier
  ds_read_b128 v[20:23], v150 offset:0
  ds_read_b64_tr_b16 v[52:53], v158 offset:0
  ds_read_b64_tr_b16 v[54:55], v158 offset:512
  ds_read_b128 v[24:27], v151 offset:0
  ds_read_b64_tr_b16 v[56:57], v158 offset:2048
  ds_read_b64_tr_b16 v[58:59], v158 offset:2560
  v_mfma_f32_32x32x16_bf16 v[116:131], v[76:79], v[44:47], v[116:131]
  s_add_u32 s30, s12, 8389760
  s_addc_u32 s31, s13, 0
  global_load_dwordx4 v[202:205], v162, s[30:31]
  global_load_dwordx4 v[206:209], v163, s[30:31]
  s_add_u32 s32, s8, 589824
  s_addc_u32 s33, s9, 0
  global_load_dwordx4 v[210:213], v164, s[32:33]
  s_add_u32 s32, s8, 598016
  s_addc_u32 s33, s9, 0
  global_load_dwordx4 v[214:217], v164, s[32:33]
  s_add_u32 s30, s12, 8389888
  s_addc_u32 s31, s13, 0
  global_load_dwordx4 v[218:221], v162, s[30:31]
  global_load_dwordx4 v[222:225], v163, s[30:31]
  s_add_u32 s32, s8, 655360
  s_addc_u32 s33, s9, 0
  global_load_dwordx4 v[226:229], v164, s[32:33]
  s_add_u32 s32, s8, 663552
  s_addc_u32 s33, s9, 0
  global_load_dwordx4 v[230:233], v164, s[32:33]
  ds_read_b128 v[28:31], v152 offset:0
  ds_read_b64_tr_b16 v[60:61], v158 offset:4096
  ds_read_b64_tr_b16 v[62:63], v158 offset:4608
  ds_read_b128 v[32:35], v153 offset:0
  ds_read_b64_tr_b16 v[64:65], v158 offset:6144
  ds_read_b64_tr_b16 v[66:67], v158 offset:6656
  v_mfma_f32_32x32x16_bf16 v[116:131], v[80:83], v[48:51], v[116:131]
  ds_read_b128 v[36:39], v150 offset:16384
  ds_read_b64_tr_b16 v[68:69], v158 offset:16384
  ds_read_b64_tr_b16 v[70:71], v158 offset:16896
  s_waitcnt lgkmcnt(12)
  v_mfma_f32_32x32x16_bf16 v[116:131], v[52:55], v[20:23], v[116:131]
  ds_read_b128 v[40:43], v151 offset:16384
  ds_read_b64_tr_b16 v[72:73], v158 offset:18432
  ds_read_b64_tr_b16 v[74:75], v158 offset:18944
  s_waitcnt lgkmcnt(12)
  v_mfma_f32_32x32x16_bf16 v[116:131], v[56:59], v[24:27], v[116:131]
  ds_read_b128 v[44:47], v152 offset:16384
  ds_read_b64_tr_b16 v[76:77], v158 offset:20480
  ds_read_b64_tr_b16 v[78:79], v158 offset:20992
  s_waitcnt lgkmcnt(12)
  v_mfma_f32_32x32x16_bf16 v[116:131], v[60:63], v[28:31], v[116:131]
  ds_read_b128 v[48:51], v153 offset:16384
  ds_read_b64_tr_b16 v[80:81], v158 offset:22528
  ds_read_b64_tr_b16 v[82:83], v158 offset:23040
  s_waitcnt lgkmcnt(12)
  v_mfma_f32_32x32x16_bf16 v[116:131], v[64:67], v[32:35], v[116:131]
  s_waitcnt lgkmcnt(9)
  v_mfma_f32_32x32x16_bf16 v[116:131], v[68:71], v[36:39], v[116:131]
  s_waitcnt vmcnt(12)
  ds_write_b128 v166, v[234:237] offset:32768
  ds_write_b128 v166, v[238:241] offset:33792
  ds_write_b128 v165, v[242:245] offset:32768
  ds_write_b128 v165, v[246:249] offset:33792
  ds_write_b128 v166, v[170:173] offset:49152
  ds_write_b128 v166, v[174:177] offset:50176
  ds_write_b128 v165, v[178:181] offset:49152
  ds_write_b128 v165, v[182:185] offset:50176
  s_waitcnt lgkmcnt(14)
  v_mfma_f32_32x32x16_bf16 v[116:131], v[72:75], v[40:43], v[116:131]
  s_waitcnt lgkmcnt(0)
  s_barrier
  ds_read_b128 v[20:23], v150 offset:32768
  ds_read_b64_tr_b16 v[52:53], v158 offset:32768
  ds_read_b64_tr_b16 v[54:55], v158 offset:33280
  ds_read_b128 v[24:27], v151 offset:32768
  ds_read_b64_tr_b16 v[56:57], v158 offset:34816
  ds_read_b64_tr_b16 v[58:59], v158 offset:35328
  v_mfma_f32_32x32x16_bf16 v[116:131], v[76:79], v[44:47], v[116:131]
  s_add_u32 s30, s12, 8390016
  s_addc_u32 s31, s13, 0
  global_load_dwordx4 v[234:237], v162, s[30:31]
  global_load_dwordx4 v[238:241], v163, s[30:31]
  s_add_u32 s32, s8, 720896
  s_addc_u32 s33, s9, 0
  global_load_dwordx4 v[242:245], v164, s[32:33]
  s_add_u32 s32, s8, 729088
  s_addc_u32 s33, s9, 0
  global_load_dwordx4 v[246:249], v164, s[32:33]
  s_add_u32 s30, s12, 8390144
  s_addc_u32 s31, s13, 0
  global_load_dwordx4 v[170:173], v162, s[30:31]
  global_load_dwordx4 v[174:177], v163, s[30:31]
  s_add_u32 s32, s8, 786432
  s_addc_u32 s33, s9, 0
  global_load_dwordx4 v[178:181], v164, s[32:33]
  s_add_u32 s32, s8, 794624
  s_addc_u32 s33, s9, 0
  global_load_dwordx4 v[182:185], v164, s[32:33]
  ds_read_b128 v[28:31], v152 offset:32768
  ds_read_b64_tr_b16 v[60:61], v158 offset:36864
  ds_read_b64_tr_b16 v[62:63], v158 offset:37376
  ds_read_b128 v[32:35], v153 offset:32768
  ds_read_b64_tr_b16 v[64:65], v158 offset:38912
  ds_read_b64_tr_b16 v[66:67], v158 offset:39424
  v_mfma_f32_32x32x16_bf16 v[116:131], v[80:83], v[48:51], v[116:131]
  ds_read_b128 v[36:39], v150 offset:49152
  ds_read_b64_tr_b16 v[68:69], v158 offset:49152
  ds_read_b64_tr_b16 v[70:71], v158 offset:49664
  s_waitcnt lgkmcnt(12)
  v_mfma_f32_32x32x16_bf16 v[116:131], v[52:55], v[20:23], v[116:131]
  ds_read_b128 v[40:43], v151 offset:49152
  ds_read_b64_tr_b16 v[72:73], v158 offset:51200
  ds_read_b64_tr_b16 v[74:75], v158 offset:51712
  s_waitcnt lgkmcnt(12)
  v_mfma_f32_32x32x16_bf16 v[116:131], v[56:59], v[24:27], v[116:131]
  ds_read_b128 v[44:47], v152 offset:49152
  ds_read_b64_tr_b16 v[76:77], v158 offset:53248
  ds_read_b64_tr_b16 v[78:79], v158 offset:53760
  s_waitcnt lgkmcnt(12)
  v_mfma_f32_32x32x16_bf16 v[116:131], v[60:63], v[28:31], v[116:131]
  ds_read_b128 v[48:51], v153 offset:49152
  ds_read_b64_tr_b16 v[80:81], v158 offset:55296
  ds_read_b64_tr_b16 v[82:83], v158 offset:55808
  s_waitcnt lgkmcnt(12)
  v_mfma_f32_32x32x16_bf16 v[116:131], v[64:67], v[32:35], v[116:131]
  s_waitcnt lgkmcnt(9)
  v_mfma_f32_32x32x16_bf16 v[116:131], v[68:71], v[36:39], v[116:131]
  s_waitcnt vmcnt(12)
  ds_write_b128 v166, v[186:189] offset:0
  ds_write_b128 v166, v[190:193] offset:1024
  ds_write_b128 v165, v[194:197] offset:0
  ds_write_b128 v165, v[198:201] offset:1024
  ds_write_b128 v166, v[202:205] offset:16384
  ds_write_b128 v166, v[206:209] offset:17408
  ds_write_b128 v165, v[210:213] offset:16384
  ds_write_b128 v165, v[214:217] offset:17408
  s_waitcnt lgkmcnt(14)
  v_mfma_f32_32x32x16_bf16 v[116:131], v[72:75], v[40:43], v[116:131]
  s_waitcnt lgkmcnt(0)
  s_barrier
  ds_read_b128 v[20:23], v150 offset:0
  ds_read_b64_tr_b16 v[52:53], v158 offset:0
  ds_read_b64_tr_b16 v[54:55], v158 offset:512
  ds_read_b128 v[24:27], v151 offset:0
  ds_read_b64_tr_b16 v[56:57], v158 offset:2048
  ds_read_b64_tr_b16 v[58:59], v158 offset:2560
  v_mfma_f32_32x32x16_bf16 v[116:131], v[76:79], v[44:47], v[116:131]
  s_add_u32 s30, s12, 8390272
  s_addc_u32 s31, s13, 0
  global_load_dwordx4 v[186:189], v162, s[30:31]
  global_load_dwordx4 v[190:193], v163, s[30:31]
  s_add_u32 s32, s8, 851968
  s_addc_u32 s33, s9, 0
  global_load_dwordx4 v[194:197], v164, s[32:33]
  s_add_u32 s32, s8, 860160
  s_addc_u32 s33, s9, 0
  global_load_dwordx4 v[198:201], v164, s[32:33]
  s_add_u32 s30, s12, 8390400
  s_addc_u32 s31, s13, 0
  global_load_dwordx4 v[202:205], v162, s[30:31]
  global_load_dwordx4 v[206:209], v163, s[30:31]
  s_add_u32 s32, s8, 917504
  s_addc_u32 s33, s9, 0
  global_load_dwordx4 v[210:213], v164, s[32:33]
  s_add_u32 s32, s8, 925696
  s_addc_u32 s33, s9, 0
  global_load_dwordx4 v[214:217], v164, s[32:33]
  ds_read_b128 v[28:31], v152 offset:0
  ds_read_b64_tr_b16 v[60:61], v158 offset:4096
  ds_read_b64_tr_b16 v[62:63], v158 offset:4608
  ds_read_b128 v[32:35], v153 offset:0
  ds_read_b64_tr_b16 v[64:65], v158 offset:6144
  ds_read_b64_tr_b16 v[66:67], v158 offset:6656
  v_mfma_f32_32x32x16_bf16 v[116:131], v[80:83], v[48:51], v[116:131]
  ds_read_b128 v[36:39], v150 offset:16384
  ds_read_b64_tr_b16 v[68:69], v158 offset:16384
  ds_read_b64_tr_b16 v[70:71], v158 offset:16896
  s_waitcnt lgkmcnt(12)
  v_mfma_f32_32x32x16_bf16 v[116:131], v[52:55], v[20:23], v[116:131]
  ds_read_b128 v[40:43], v151 offset:16384
  ds_read_b64_tr_b16 v[72:73], v158 offset:18432
  ds_read_b64_tr_b16 v[74:75], v158 offset:18944
  s_waitcnt lgkmcnt(12)
  v_mfma_f32_32x32x16_bf16 v[116:131], v[56:59], v[24:27], v[116:131]
  ds_read_b128 v[44:47], v152 offset:16384
  ds_read_b64_tr_b16 v[76:77], v158 offset:20480
  ds_read_b64_tr_b16 v[78:79], v158 offset:20992
  s_waitcnt lgkmcnt(12)
  v_mfma_f32_32x32x16_bf16 v[116:131], v[60:63], v[28:31], v[116:131]
  ds_read_b128 v[48:51], v153 offset:16384
  ds_read_b64_tr_b16 v[80:81], v158 offset:22528
  ds_read_b64_tr_b16 v[82:83], v158 offset:23040
  s_waitcnt lgkmcnt(12)
  v_mfma_f32_32x32x16_bf16 v[116:131], v[64:67], v[32:35], v[116:131]
  s_waitcnt lgkmcnt(9)
  v_mfma_f32_32x32x16_bf16 v[116:131], v[68:71], v[36:39], v[116:131]
  s_waitcnt vmcnt(12)
  ds_write_b128 v166, v[218:221] offset:32768
  ds_write_b128 v166, v[222:225] offset:33792
  ds_write_b128 v165, v[226:229] offset:32768
  ds_write_b128 v165, v[230:233] offset:33792
  ds_write_b128 v166, v[234:237] offset:49152
  ds_write_b128 v166, v[238:241] offset:50176
  ds_write_b128 v165, v[242:245] offset:49152
  ds_write_b128 v165, v[246:249] offset:50176
  s_waitcnt lgkmcnt(14)
  v_mfma_f32_32x32x16_bf16 v[116:131], v[72:75], v[40:43], v[116:131]
  s_waitcnt lgkmcnt(0)
  s_barrier
  ds_read_b128 v[20:23], v150 offset:32768
  ds_read_b64_tr_b16 v[52:53], v158 offset:32768
  ds_read_b64_tr_b16 v[54:55], v158 offset:33280
  ds_read_b128 v[24:27], v151 offset:32768
  ds_read_b64_tr_b16 v[56:57], v158 offset:34816
  ds_read_b64_tr_b16 v[58:59], v158 offset:35328
  v_mfma_f32_32x32x16_bf16 v[116:131], v[76:79], v[44:47], v[116:131]
  s_add_u32 s30, s12, 8390528
  s_addc_u32 s31, s13, 0
  global_load_dwordx4 v[218:221], v162, s[30:31]
  global_load_dwordx4 v[222:225], v163, s[30:31]
  s_add_u32 s32, s8, 983040
  s_addc_u32 s33, s9, 0
  global_load_dwordx4 v[226:229], v164, s[32:33]
  s_add_u32 s32, s8, 991232
  s_addc_u32 s33, s9, 0
  global_load_dwordx4 v[230:233], v164, s[32:33]
  s_add_u32 s30, s12, 8390656
  s_addc_u32 s31, s13, 0
  global_load_dwordx4 v[234:237], v162, s[30:31]
  global_load_dwordx4 v[238:241], v163, s[30:31]
  s_add_u32 s32, s8, 1048576
  s_addc_u32 s33, s9, 0
  global_load_dwordx4 v[242:245], v164, s[32:33]
  s_add_u32 s32, s8, 1056768
  s_addc_u32 s33, s9, 0
  global_load_dwordx4 v[246:249], v164, s[32:33]
  ds_read_b128 v[28:31], v152 offset:32768
  ds_read_b64_tr_b16 v[60:61], v158 offset:36864
  ds_read_b64_tr_b16 v[62:63], v158 offset:37376
  ds_read_b128 v[32:35], v153 offset:32768
  ds_read_b64_tr_b16 v[64:65], v158 offset:38912
  ds_read_b64_tr_b16 v[66:67], v158 offset:39424
  v_mfma_f32_32x32x16_bf16 v[116:131], v[80:83], v[48:51], v[116:131]
  ds_read_b128 v[36:39], v150 offset:49152
  ds_read_b64_tr_b16 v[68:69], v158 offset:49152
  ds_read_b64_tr_b16 v[70:71], v158 offset:49664
  s_waitcnt lgkmcnt(12)
  v_mfma_f32_32x32x16_bf16 v[116:131], v[52:55], v[20:23], v[116:131]
  ds_read_b128 v[40:43], v151 offset:49152
  ds_read_b64_tr_b16 v[72:73], v158 offset:51200
  ds_read_b64_tr_b16 v[74:75], v158 offset:51712
  s_waitcnt lgkmcnt(12)
  v_mfma_f32_32x32x16_bf16 v[116:131], v[56:59], v[24:27], v[116:131]
  ds_read_b128 v[44:47], v152 offset:49152
  ds_read_b64_tr_b16 v[76:77], v158 offset:53248
  ds_read_b64_tr_b16 v[78:79], v158 offset:53760
  s_waitcnt lgkmcnt(12)
  v_mfma_f32_32x32x16_bf16 v[116:131], v[60:63], v[28:31], v[116:131]
  ds_read_b128 v[48:51], v153 offset:49152
  ds_read_b64_tr_b16 v[80:81], v158 offset:55296
  ds_read_b64_tr_b16 v[82:83], v158 offset:55808
  s_waitcnt lgkmcnt(12)
  v_mfma_f32_32x32x16_bf16 v[116:131], v[64:67], v[32:35], v[116:131]
  s_waitcnt lgkmcnt(9)
  v_mfma_f32_32x32x16_bf16 v[116:131], v[68:71], v[36:39], v[116:131]
  s_waitcnt vmcnt(12)
  ds_write_b128 v166, v[170:173] offset:0
  ds_write_b128 v166, v[174:177] offset:1024
  ds_write_b128 v165, v[178:181] offset:0
  ds_write_b128 v165, v[182:185] offset:1024
  ds_write_b128 v166, v[186:189] offset:16384
  ds_write_b128 v166, v[190:193] offset:17408
  ds_write_b128 v165, v[194:197] offset:16384
  ds_write_b128 v165, v[198:201] offset:17408
  s_waitcnt lgkmcnt(14)
  v_mfma_f32_32x32x16_bf16 v[116:131], v[72:75], v[40:43], v[116:131]
  s_waitcnt lgkmcnt(0)
  s_barrier
  ds_read_b128 v[20:23], v150 offset:0
  ds_read_b64_tr_b16 v[52:53], v158 offset:0
  ds_read_b64_tr_b16 v[54:55], v158 offset:512
  ds_read_b128 v[24:27], v151 offset:0
  ds_read_b64_tr_b16 v[56:57], v158 offset:2048
  ds_read_b64_tr_b16 v[58:59], v158 offset:2560
  v_mfma_f32_32x32x16_bf16 v[116:131], v[76:79], v[44:47], v[116:131]
  s_add_u32 s30, s12, 8390784
  s_addc_u32 s31, s13, 0
  global_load_dwordx4 v[170:173], v162, s[30:31]
  global_load_dwordx4 v[174:177], v163, s[30:31]
  s_add_u32 s32, s8, 1114112
  s_addc_u32 s33, s9, 0
  global_load_dwordx4 v[178:181], v164, s[32:33]
  s_add_u32 s32, s8, 1122304
  s_addc_u32 s33, s9, 0
  global_load_dwordx4 v[182:185], v164, s[32:33]
  s_add_u32 s30, s12, 8390912
  s_addc_u32 s31, s13, 0
  global_load_dwordx4 v[186:189], v162, s[30:31]
  global_load_dwordx4 v[190:193], v163, s[30:31]
  s_add_u32 s32, s8, 1179648
  s_addc_u32 s33, s9, 0
  global_load_dwordx4 v[194:197], v164, s[32:33]
  s_add_u32 s32, s8, 1187840
  s_addc_u32 s33, s9, 0
  global_load_dwordx4 v[198:201], v164, s[32:33]
  ds_read_b128 v[28:31], v152 offset:0
  ds_read_b64_tr_b16 v[60:61], v158 offset:4096
  ds_read_b64_tr_b16 v[62:63], v158 offset:4608
  ds_read_b128 v[32:35], v153 offset:0
  ds_read_b64_tr_b16 v[64:65], v158 offset:6144
  ds_read_b64_tr_b16 v[66:67], v158 offset:6656
  v_mfma_f32_32x32x16_bf16 v[116:131], v[80:83], v[48:51], v[116:131]
  ds_read_b128 v[36:39], v150 offset:16384
  ds_read_b64_tr_b16 v[68:69], v158 offset:16384
  ds_read_b64_tr_b16 v[70:71], v158 offset:16896
  s_waitcnt lgkmcnt(12)
  v_mfma_f32_32x32x16_bf16 v[116:131], v[52:55], v[20:23], v[116:131]
  ds_read_b128 v[40:43], v151 offset:16384
  ds_read_b64_tr_b16 v[72:73], v158 offset:18432
  ds_read_b64_tr_b16 v[74:75], v158 offset:18944
  s_waitcnt lgkmcnt(12)
  v_mfma_f32_32x32x16_bf16 v[116:131], v[56:59], v[24:27], v[116:131]
  ds_read_b128 v[44:47], v152 offset:16384
  ds_read_b64_tr_b16 v[76:77], v158 offset:20480
  ds_read_b64_tr_b16 v[78:79], v158 offset:20992
  s_waitcnt lgkmcnt(12)
  v_mfma_f32_32x32x16_bf16 v[116:131], v[60:63], v[28:31], v[116:131]
  ds_read_b128 v[48:51], v153 offset:16384
  ds_read_b64_tr_b16 v[80:81], v158 offset:22528
  ds_read_b64_tr_b16 v[82:83], v158 offset:23040
  s_waitcnt lgkmcnt(12)
  v_mfma_f32_32x32x16_bf16 v[116:131], v[64:67], v[32:35], v[116:131]
  s_waitcnt lgkmcnt(9)
  v_mfma_f32_32x32x16_bf16 v[116:131], v[68:71], v[36:39], v[116:131]
  s_waitcnt vmcnt(12)
  ds_write_b128 v166, v[202:205] offset:32768
  ds_write_b128 v166, v[206:209] offset:33792
  ds_write_b128 v165, v[210:213] offset:32768
  ds_write_b128 v165, v[214:217] offset:33792
  ds_write_b128 v166, v[218:221] offset:49152
  ds_write_b128 v166, v[222:225] offset:50176
  ds_write_b128 v165, v[226:229] offset:49152
  ds_write_b128 v165, v[230:233] offset:50176
  s_waitcnt lgkmcnt(14)
  v_mfma_f32_32x32x16_bf16 v[116:131], v[72:75], v[40:43], v[116:131]
  s_waitcnt lgkmcnt(0)
  s_barrier
  ds_read_b128 v[20:23], v150 offset:32768
  ds_read_b64_tr_b16 v[52:53], v158 offset:32768
  ds_read_b64_tr_b16 v[54:55], v158 offset:33280
  ds_read_b128 v[24:27], v151 offset:32768
  ds_read_b64_tr_b16 v[56:57], v158 offset:34816
  ds_read_b64_tr_b16 v[58:59], v158 offset:35328
  v_mfma_f32_32x32x16_bf16 v[116:131], v[76:79], v[44:47], v[116:131]
  s_add_u32 s30, s12, 8391040
  s_addc_u32 s31, s13, 0
  global_load_dwordx4 v[202:205], v162, s[30:31]
  global_load_dwordx4 v[206:209], v163, s[30:31]
  s_add_u32 s32, s8, 1245184
  s_addc_u32 s33, s9, 0
  global_load_dwordx4 v[210:213], v164, s[32:33]
  s_add_u32 s32, s8, 1253376
  s_addc_u32 s33, s9, 0
  global_load_dwordx4 v[214:217], v164, s[32:33]
  s_add_u32 s30, s12, 8391168
  s_addc_u32 s31, s13, 0
  global_load_dwordx4 v[218:221], v162, s[30:31]
  global_load_dwordx4 v[222:225], v163, s[30:31]
  s_add_u32 s32, s8, 1310720
  s_addc_u32 s33, s9, 0
  global_load_dwordx4 v[226:229], v164, s[32:33]
  s_add_u32 s32, s8, 1318912
  s_addc_u32 s33, s9, 0
  global_load_dwordx4 v[230:233], v164, s[32:33]
  ds_read_b128 v[28:31], v152 offset:32768
  ds_read_b64_tr_b16 v[60:61], v158 offset:36864
  ds_read_b64_tr_b16 v[62:63], v158 offset:37376
  ds_read_b128 v[32:35], v153 offset:32768
  ds_read_b64_tr_b16 v[64:65], v158 offset:38912
  ds_read_b64_tr_b16 v[66:67], v158 offset:39424
  v_mfma_f32_32x32x16_bf16 v[116:131], v[80:83], v[48:51], v[116:131]
  ds_read_b128 v[36:39], v150 offset:49152
  ds_read_b64_tr_b16 v[68:69], v158 offset:49152
  ds_read_b64_tr_b16 v[70:71], v158 offset:49664
  s_waitcnt lgkmcnt(12)
  v_mfma_f32_32x32x16_bf16 v[116:131], v[52:55], v[20:23], v[116:131]
  ds_read_b128 v[40:43], v151 offset:49152
  ds_read_b64_tr_b16 v[72:73], v158 offset:51200
  ds_read_b64_tr_b16 v[74:75], v158 offset:51712
  s_waitcnt lgkmcnt(12)
  v_mfma_f32_32x32x16_bf16 v[116:131], v[56:59], v[24:27], v[116:131]
  ds_read_b128 v[44:47], v152 offset:49152
  ds_read_b64_tr_b16 v[76:77], v158 offset:53248
  ds_read_b64_tr_b16 v[78:79], v158 offset:53760
  s_waitcnt lgkmcnt(12)
  v_mfma_f32_32x32x16_bf16 v[116:131], v[60:63], v[28:31], v[116:131]
  ds_read_b128 v[48:51], v153 offset:49152
  ds_read_b64_tr_b16 v[80:81], v158 offset:55296
  ds_read_b64_tr_b16 v[82:83], v158 offset:55808
  s_waitcnt lgkmcnt(12)
  v_mfma_f32_32x32x16_bf16 v[116:131], v[64:67], v[32:35], v[116:131]
  s_waitcnt lgkmcnt(9)
  v_mfma_f32_32x32x16_bf16 v[116:131], v[68:71], v[36:39], v[116:131]
  s_waitcnt vmcnt(12)
  ds_write_b128 v166, v[234:237] offset:0
  ds_write_b128 v166, v[238:241] offset:1024
  ds_write_b128 v165, v[242:245] offset:0
  ds_write_b128 v165, v[246:249] offset:1024
  ds_write_b128 v166, v[170:173] offset:16384
  ds_write_b128 v166, v[174:177] offset:17408
  ds_write_b128 v165, v[178:181] offset:16384
  ds_write_b128 v165, v[182:185] offset:17408
  s_waitcnt lgkmcnt(14)
  v_mfma_f32_32x32x16_bf16 v[116:131], v[72:75], v[40:43], v[116:131]
  s_waitcnt lgkmcnt(0)
  s_barrier
  ds_read_b128 v[20:23], v150 offset:0
  ds_read_b64_tr_b16 v[52:53], v158 offset:0
  ds_read_b64_tr_b16 v[54:55], v158 offset:512
  ds_read_b128 v[24:27], v151 offset:0
  ds_read_b64_tr_b16 v[56:57], v158 offset:2048
  ds_read_b64_tr_b16 v[58:59], v158 offset:2560
  v_mfma_f32_32x32x16_bf16 v[116:131], v[76:79], v[44:47], v[116:131]
  s_add_u32 s30, s12, 8391296
  s_addc_u32 s31, s13, 0
  global_load_dwordx4 v[234:237], v162, s[30:31]
  global_load_dwordx4 v[238:241], v163, s[30:31]
  s_add_u32 s32, s8, 1376256
  s_addc_u32 s33, s9, 0
  global_load_dwordx4 v[242:245], v164, s[32:33]
  s_add_u32 s32, s8, 1384448
  s_addc_u32 s33, s9, 0
  global_load_dwordx4 v[246:249], v164, s[32:33]
  s_add_u32 s30, s12, 8391424
  s_addc_u32 s31, s13, 0
  global_load_dwordx4 v[170:173], v162, s[30:31]
  global_load_dwordx4 v[174:177], v163, s[30:31]
  s_add_u32 s32, s8, 1441792
  s_addc_u32 s33, s9, 0
  global_load_dwordx4 v[178:181], v164, s[32:33]
  s_add_u32 s32, s8, 1449984
  s_addc_u32 s33, s9, 0
  global_load_dwordx4 v[182:185], v164, s[32:33]
  ds_read_b128 v[28:31], v152 offset:0
  ds_read_b64_tr_b16 v[60:61], v158 offset:4096
  ds_read_b64_tr_b16 v[62:63], v158 offset:4608
  ds_read_b128 v[32:35], v153 offset:0
  ds_read_b64_tr_b16 v[64:65], v158 offset:6144
  ds_read_b64_tr_b16 v[66:67], v158 offset:6656
  v_mfma_f32_32x32x16_bf16 v[116:131], v[80:83], v[48:51], v[116:131]
  ds_read_b128 v[36:39], v150 offset:16384
  ds_read_b64_tr_b16 v[68:69], v158 offset:16384
  ds_read_b64_tr_b16 v[70:71], v158 offset:16896
  s_waitcnt lgkmcnt(12)
  v_mfma_f32_32x32x16_bf16 v[116:131], v[52:55], v[20:23], v[116:131]
  ds_read_b128 v[40:43], v151 offset:16384
  ds_read_b64_tr_b16 v[72:73], v158 offset:18432
  ds_read_b64_tr_b16 v[74:75], v158 offset:18944
  s_waitcnt lgkmcnt(12)
  v_mfma_f32_32x32x16_bf16 v[116:131], v[56:59], v[24:27], v[116:131]
  ds_read_b128 v[44:47], v152 offset:16384
  ds_read_b64_tr_b16 v[76:77], v158 offset:20480
  ds_read_b64_tr_b16 v[78:79], v158 offset:20992
  s_waitcnt lgkmcnt(12)
  v_mfma_f32_32x32x16_bf16 v[116:131], v[60:63], v[28:31], v[116:131]
  ds_read_b128 v[48:51], v153 offset:16384
  ds_read_b64_tr_b16 v[80:81], v158 offset:22528
  ds_read_b64_tr_b16 v[82:83], v158 offset:23040
  s_waitcnt lgkmcnt(12)
  v_mfma_f32_32x32x16_bf16 v[116:131], v[64:67], v[32:35], v[116:131]
  s_waitcnt lgkmcnt(9)
  v_mfma_f32_32x32x16_bf16 v[116:131], v[68:71], v[36:39], v[116:131]
  s_waitcnt vmcnt(12)
  ds_write_b128 v166, v[186:189] offset:32768
  ds_write_b128 v166, v[190:193] offset:33792
  ds_write_b128 v165, v[194:197] offset:32768
  ds_write_b128 v165, v[198:201] offset:33792
  ds_write_b128 v166, v[202:205] offset:49152
  ds_write_b128 v166, v[206:209] offset:50176
  ds_write_b128 v165, v[210:213] offset:49152
  ds_write_b128 v165, v[214:217] offset:50176
  s_waitcnt lgkmcnt(14)
  v_mfma_f32_32x32x16_bf16 v[116:131], v[72:75], v[40:43], v[116:131]
  s_waitcnt lgkmcnt(0)
  s_barrier
  ds_read_b128 v[20:23], v150 offset:32768
  ds_read_b64_tr_b16 v[52:53], v158 offset:32768
  ds_read_b64_tr_b16 v[54:55], v158 offset:33280
  ds_read_b128 v[24:27], v151 offset:32768
  ds_read_b64_tr_b16 v[56:57], v158 offset:34816
  ds_read_b64_tr_b16 v[58:59], v158 offset:35328
  v_mfma_f32_32x32x16_bf16 v[116:131], v[76:79], v[44:47], v[116:131]
  s_add_u32 s30, s12, 8391552
  s_addc_u32 s31, s13, 0
  global_load_dwordx4 v[186:189], v162, s[30:31]
  global_load_dwordx4 v[190:193], v163, s[30:31]
  s_add_u32 s32, s8, 1507328
  s_addc_u32 s33, s9, 0
  global_load_dwordx4 v[194:197], v164, s[32:33]
  s_add_u32 s32, s8, 1515520
  s_addc_u32 s33, s9, 0
  global_load_dwordx4 v[198:201], v164, s[32:33]
  s_add_u32 s30, s12, 8391680
  s_addc_u32 s31, s13, 0
  global_load_dwordx4 v[202:205], v162, s[30:31]
  global_load_dwordx4 v[206:209], v163, s[30:31]
  s_add_u32 s32, s8, 1572864
  s_addc_u32 s33, s9, 0
  global_load_dwordx4 v[210:213], v164, s[32:33]
  s_add_u32 s32, s8, 1581056
  s_addc_u32 s33, s9, 0
  global_load_dwordx4 v[214:217], v164, s[32:33]
  ds_read_b128 v[28:31], v152 offset:32768
  ds_read_b64_tr_b16 v[60:61], v158 offset:36864
  ds_read_b64_tr_b16 v[62:63], v158 offset:37376
  ds_read_b128 v[32:35], v153 offset:32768
  ds_read_b64_tr_b16 v[64:65], v158 offset:38912
  ds_read_b64_tr_b16 v[66:67], v158 offset:39424
  v_mfma_f32_32x32x16_bf16 v[116:131], v[80:83], v[48:51], v[116:131]
  ds_read_b128 v[36:39], v150 offset:49152
  ds_read_b64_tr_b16 v[68:69], v158 offset:49152
  ds_read_b64_tr_b16 v[70:71], v158 offset:49664
  s_waitcnt lgkmcnt(12)
  v_mfma_f32_32x32x16_bf16 v[116:131], v[52:55], v[20:23], v[116:131]
  ds_read_b128 v[40:43], v151 offset:49152
  ds_read_b64_tr_b16 v[72:73], v158 offset:51200
  ds_read_b64_tr_b16 v[74:75], v158 offset:51712
  s_waitcnt lgkmcnt(12)
  v_mfma_f32_32x32x16_bf16 v[116:131], v[56:59], v[24:27], v[116:131]
  ds_read_b128 v[44:47], v152 offset:49152
  ds_read_b64_tr_b16 v[76:77], v158 offset:53248
  ds_read_b64_tr_b16 v[78:79], v158 offset:53760
  s_waitcnt lgkmcnt(12)
  v_mfma_f32_32x32x16_bf16 v[116:131], v[60:63], v[28:31], v[116:131]
  ds_read_b128 v[48:51], v153 offset:49152
  ds_read_b64_tr_b16 v[80:81], v158 offset:55296
  ds_read_b64_tr_b16 v[82:83], v158 offset:55808
  s_waitcnt lgkmcnt(12)
  v_mfma_f32_32x32x16_bf16 v[116:131], v[64:67], v[32:35], v[116:131]
  s_waitcnt lgkmcnt(9)
  v_mfma_f32_32x32x16_bf16 v[116:131], v[68:71], v[36:39], v[116:131]
  s_waitcnt vmcnt(12)
  ds_write_b128 v166, v[218:221] offset:0
  ds_write_b128 v166, v[222:225] offset:1024
  ds_write_b128 v165, v[226:229] offset:0
  ds_write_b128 v165, v[230:233] offset:1024
  ds_write_b128 v166, v[234:237] offset:16384
  ds_write_b128 v166, v[238:241] offset:17408
  ds_write_b128 v165, v[242:245] offset:16384
  ds_write_b128 v165, v[246:249] offset:17408
  s_waitcnt lgkmcnt(14)
  v_mfma_f32_32x32x16_bf16 v[116:131], v[72:75], v[40:43], v[116:131]
  s_waitcnt lgkmcnt(0)
  s_barrier
  ds_read_b128 v[20:23], v150 offset:0
  ds_read_b64_tr_b16 v[52:53], v158 offset:0
  ds_read_b64_tr_b16 v[54:55], v158 offset:512
  ds_read_b128 v[24:27], v151 offset:0
  ds_read_b64_tr_b16 v[56:57], v158 offset:2048
  ds_read_b64_tr_b16 v[58:59], v158 offset:2560
  v_mfma_f32_32x32x16_bf16 v[116:131], v[76:79], v[44:47], v[116:131]
  s_add_u32 s30, s12, 8391808
  s_addc_u32 s31, s13, 0
  global_load_dwordx4 v[218:221], v162, s[30:31]
  global_load_dwordx4 v[222:225], v163, s[30:31]
  s_add_u32 s32, s8, 1638400
  s_addc_u32 s33, s9, 0
  global_load_dwordx4 v[226:229], v164, s[32:33]
  s_add_u32 s32, s8, 1646592
  s_addc_u32 s33, s9, 0
  global_load_dwordx4 v[230:233], v164, s[32:33]
  s_add_u32 s30, s12, 8391936
  s_addc_u32 s31, s13, 0
  global_load_dwordx4 v[234:237], v162, s[30:31]
  global_load_dwordx4 v[238:241], v163, s[30:31]
  s_add_u32 s32, s8, 1703936
  s_addc_u32 s33, s9, 0
  global_load_dwordx4 v[242:245], v164, s[32:33]
  s_add_u32 s32, s8, 1712128
  s_addc_u32 s33, s9, 0
  global_load_dwordx4 v[246:249], v164, s[32:33]
  ds_read_b128 v[28:31], v152 offset:0
  ds_read_b64_tr_b16 v[60:61], v158 offset:4096
  ds_read_b64_tr_b16 v[62:63], v158 offset:4608
  ds_read_b128 v[32:35], v153 offset:0
  ds_read_b64_tr_b16 v[64:65], v158 offset:6144
  ds_read_b64_tr_b16 v[66:67], v158 offset:6656
  v_mfma_f32_32x32x16_bf16 v[116:131], v[80:83], v[48:51], v[116:131]
  ds_read_b128 v[36:39], v150 offset:16384
  ds_read_b64_tr_b16 v[68:69], v158 offset:16384
  ds_read_b64_tr_b16 v[70:71], v158 offset:16896
  s_waitcnt lgkmcnt(12)
  v_mfma_f32_32x32x16_bf16 v[116:131], v[52:55], v[20:23], v[116:131]
  ds_read_b128 v[40:43], v151 offset:16384
  ds_read_b64_tr_b16 v[72:73], v158 offset:18432
  ds_read_b64_tr_b16 v[74:75], v158 offset:18944
  s_waitcnt lgkmcnt(12)
  v_mfma_f32_32x32x16_bf16 v[116:131], v[56:59], v[24:27], v[116:131]
  ds_read_b128 v[44:47], v152 offset:16384
  ds_read_b64_tr_b16 v[76:77], v158 offset:20480
  ds_read_b64_tr_b16 v[78:79], v158 offset:20992
  s_waitcnt lgkmcnt(12)
  v_mfma_f32_32x32x16_bf16 v[116:131], v[60:63], v[28:31], v[116:131]
  ds_read_b128 v[48:51], v153 offset:16384
  ds_read_b64_tr_b16 v[80:81], v158 offset:22528
  ds_read_b64_tr_b16 v[82:83], v158 offset:23040
  s_waitcnt lgkmcnt(12)
  v_mfma_f32_32x32x16_bf16 v[116:131], v[64:67], v[32:35], v[116:131]
  s_waitcnt lgkmcnt(9)
  v_mfma_f32_32x32x16_bf16 v[116:131], v[68:71], v[36:39], v[116:131]
  s_waitcnt vmcnt(12)
  ds_write_b128 v166, v[170:173] offset:32768
  ds_write_b128 v166, v[174:177] offset:33792
  ds_write_b128 v165, v[178:181] offset:32768
  ds_write_b128 v165, v[182:185] offset:33792
  ds_write_b128 v166, v[186:189] offset:49152
  ds_write_b128 v166, v[190:193] offset:50176
  ds_write_b128 v165, v[194:197] offset:49152
  ds_write_b128 v165, v[198:201] offset:50176
  s_waitcnt lgkmcnt(14)
  v_mfma_f32_32x32x16_bf16 v[116:131], v[72:75], v[40:43], v[116:131]
  s_waitcnt lgkmcnt(0)
  s_barrier
  ds_read_b128 v[20:23], v150 offset:32768
  ds_read_b64_tr_b16 v[52:53], v158 offset:32768
  ds_read_b64_tr_b16 v[54:55], v158 offset:33280
  ds_read_b128 v[24:27], v151 offset:32768
  ds_read_b64_tr_b16 v[56:57], v158 offset:34816
  ds_read_b64_tr_b16 v[58:59], v158 offset:35328
  v_mfma_f32_32x32x16_bf16 v[116:131], v[76:79], v[44:47], v[116:131]
  s_add_u32 s30, s12, 8392064
  s_addc_u32 s31, s13, 0
  global_load_dwordx4 v[170:173], v162, s[30:31]
  global_load_dwordx4 v[174:177], v163, s[30:31]
  s_add_u32 s32, s8, 1769472
  s_addc_u32 s33, s9, 0
  global_load_dwordx4 v[178:181], v164, s[32:33]
  s_add_u32 s32, s8, 1777664
  s_addc_u32 s33, s9, 0
  global_load_dwordx4 v[182:185], v164, s[32:33]
  ds_read_b128 v[28:31], v152 offset:32768
  ds_read_b64_tr_b16 v[60:61], v158 offset:36864
  ds_read_b64_tr_b16 v[62:63], v158 offset:37376
  ds_read_b128 v[32:35], v153 offset:32768
  ds_read_b64_tr_b16 v[64:65], v158 offset:38912
  ds_read_b64_tr_b16 v[66:67], v158 offset:39424
  v_mfma_f32_32x32x16_bf16 v[116:131], v[80:83], v[48:51], v[116:131]
  ds_read_b128 v[36:39], v150 offset:49152
  ds_read_b64_tr_b16 v[68:69], v158 offset:49152
  ds_read_b64_tr_b16 v[70:71], v158 offset:49664
  s_waitcnt lgkmcnt(12)
  v_mfma_f32_32x32x16_bf16 v[116:131], v[52:55], v[20:23], v[116:131]
  ds_read_b128 v[40:43], v151 offset:49152
  ds_read_b64_tr_b16 v[72:73], v158 offset:51200
  ds_read_b64_tr_b16 v[74:75], v158 offset:51712
  s_waitcnt lgkmcnt(12)
  v_mfma_f32_32x32x16_bf16 v[116:131], v[56:59], v[24:27], v[116:131]
  ds_read_b128 v[44:47], v152 offset:49152
  ds_read_b64_tr_b16 v[76:77], v158 offset:53248
  ds_read_b64_tr_b16 v[78:79], v158 offset:53760
  s_waitcnt lgkmcnt(12)
  v_mfma_f32_32x32x16_bf16 v[116:131], v[60:63], v[28:31], v[116:131]
  ds_read_b128 v[48:51], v153 offset:49152
  ds_read_b64_tr_b16 v[80:81], v158 offset:55296
  ds_read_b64_tr_b16 v[82:83], v158 offset:55808
  s_waitcnt lgkmcnt(12)
  v_mfma_f32_32x32x16_bf16 v[116:131], v[64:67], v[32:35], v[116:131]
  s_waitcnt lgkmcnt(9)
  v_mfma_f32_32x32x16_bf16 v[116:131], v[68:71], v[36:39], v[116:131]
  s_waitcnt vmcnt(8)
  ds_write_b128 v166, v[202:205] offset:0
  ds_write_b128 v166, v[206:209] offset:1024
  ds_write_b128 v165, v[210:213] offset:0
  ds_write_b128 v165, v[214:217] offset:1024
  ds_write_b128 v166, v[218:221] offset:16384
  ds_write_b128 v166, v[222:225] offset:17408
  ds_write_b128 v165, v[226:229] offset:16384
  ds_write_b128 v165, v[230:233] offset:17408
  s_waitcnt lgkmcnt(14)
  v_mfma_f32_32x32x16_bf16 v[116:131], v[72:75], v[40:43], v[116:131]
  s_waitcnt lgkmcnt(0)
  s_barrier
  ds_read_b128 v[20:23], v150 offset:0
  ds_read_b64_tr_b16 v[52:53], v158 offset:0
  ds_read_b64_tr_b16 v[54:55], v158 offset:512
  ds_read_b128 v[24:27], v151 offset:0
  ds_read_b64_tr_b16 v[56:57], v158 offset:2048
  ds_read_b64_tr_b16 v[58:59], v158 offset:2560
  v_mfma_f32_32x32x16_bf16 v[116:131], v[76:79], v[44:47], v[116:131]
  ds_read_b128 v[28:31], v152 offset:0
  ds_read_b64_tr_b16 v[60:61], v158 offset:4096
  ds_read_b64_tr_b16 v[62:63], v158 offset:4608
  ds_read_b128 v[32:35], v153 offset:0
  ds_read_b64_tr_b16 v[64:65], v158 offset:6144
  ds_read_b64_tr_b16 v[66:67], v158 offset:6656
  v_mfma_f32_32x32x16_bf16 v[116:131], v[80:83], v[48:51], v[116:131]
  ds_read_b128 v[36:39], v150 offset:16384
  ds_read_b64_tr_b16 v[68:69], v158 offset:16384
  ds_read_b64_tr_b16 v[70:71], v158 offset:16896
  s_waitcnt lgkmcnt(12)
  v_mfma_f32_32x32x16_bf16 v[116:131], v[52:55], v[20:23], v[116:131]
  ds_read_b128 v[40:43], v151 offset:16384
  ds_read_b64_tr_b16 v[72:73], v158 offset:18432
  ds_read_b64_tr_b16 v[74:75], v158 offset:18944
  s_waitcnt lgkmcnt(12)
  v_mfma_f32_32x32x16_bf16 v[116:131], v[56:59], v[24:27], v[116:131]
  ds_read_b128 v[44:47], v152 offset:16384
  ds_read_b64_tr_b16 v[76:77], v158 offset:20480
  ds_read_b64_tr_b16 v[78:79], v158 offset:20992
  s_waitcnt lgkmcnt(12)
  v_mfma_f32_32x32x16_bf16 v[116:131], v[60:63], v[28:31], v[116:131]
  ds_read_b128 v[48:51], v153 offset:16384
  ds_read_b64_tr_b16 v[80:81], v158 offset:22528
  ds_read_b64_tr_b16 v[82:83], v158 offset:23040
  s_waitcnt lgkmcnt(12)
  v_mfma_f32_32x32x16_bf16 v[116:131], v[64:67], v[32:35], v[116:131]
  s_waitcnt lgkmcnt(9)
  v_mfma_f32_32x32x16_bf16 v[116:131], v[68:71], v[36:39], v[116:131]
  s_waitcnt vmcnt(0)
  ds_write_b128 v166, v[234:237] offset:32768
  ds_write_b128 v166, v[238:241] offset:33792
  ds_write_b128 v165, v[242:245] offset:32768
  ds_write_b128 v165, v[246:249] offset:33792
  ds_write_b128 v166, v[170:173] offset:49152
  ds_write_b128 v166, v[174:177] offset:50176
  ds_write_b128 v165, v[178:181] offset:49152
  ds_write_b128 v165, v[182:185] offset:50176
  s_waitcnt lgkmcnt(14)
  v_mfma_f32_32x32x16_bf16 v[116:131], v[72:75], v[40:43], v[116:131]
  s_waitcnt lgkmcnt(0)
  s_barrier
  ds_read_b128 v[20:23], v150 offset:32768
  ds_read_b64_tr_b16 v[52:53], v158 offset:32768
  ds_read_b64_tr_b16 v[54:55], v158 offset:33280
  ds_read_b128 v[24:27], v151 offset:32768
  ds_read_b64_tr_b16 v[56:57], v158 offset:34816
  ds_read_b64_tr_b16 v[58:59], v158 offset:35328
  v_mfma_f32_32x32x16_bf16 v[116:131], v[76:79], v[44:47], v[116:131]
  ds_read_b128 v[28:31], v152 offset:32768
  ds_read_b64_tr_b16 v[60:61], v158 offset:36864
  ds_read_b64_tr_b16 v[62:63], v158 offset:37376
  ds_read_b128 v[32:35], v153 offset:32768
  ds_read_b64_tr_b16 v[64:65], v158 offset:38912
  ds_read_b64_tr_b16 v[66:67], v158 offset:39424
  v_mfma_f32_32x32x16_bf16 v[116:131], v[80:83], v[48:51], v[116:131]
  ds_read_b128 v[36:39], v150 offset:49152
  ds_read_b64_tr_b16 v[68:69], v158 offset:49152
  ds_read_b64_tr_b16 v[70:71], v158 offset:49664
  s_waitcnt lgkmcnt(12)
  v_mfma_f32_32x32x16_bf16 v[116:131], v[52:55], v[20:23], v[116:131]
  ds_read_b128 v[40:43], v151 offset:49152
  ds_read_b64_tr_b16 v[72:73], v158 offset:51200
  ds_read_b64_tr_b16 v[74:75], v158 offset:51712
  s_waitcnt lgkmcnt(12)
  v_mfma_f32_32x32x16_bf16 v[116:131], v[56:59], v[24:27], v[116:131]
  ds_read_b128 v[44:47], v152 offset:49152
  ds_read_b64_tr_b16 v[76:77], v158 offset:53248
  ds_read_b64_tr_b16 v[78:79], v158 offset:53760
  s_waitcnt lgkmcnt(12)
  v_mfma_f32_32x32x16_bf16 v[116:131], v[60:63], v[28:31], v[116:131]
  ds_read_b128 v[48:51], v153 offset:49152
  ds_read_b64_tr_b16 v[80:81], v158 offset:55296
  ds_read_b64_tr_b16 v[82:83], v158 offset:55808
  s_waitcnt lgkmcnt(12)
  v_mfma_f32_32x32x16_bf16 v[116:131], v[64:67], v[32:35], v[116:131]
  s_waitcnt lgkmcnt(9)
  v_mfma_f32_32x32x16_bf16 v[116:131], v[68:71], v[36:39], v[116:131]
  s_waitcnt lgkmcnt(6)
  v_mfma_f32_32x32x16_bf16 v[116:131], v[72:75], v[40:43], v[116:131]
  s_waitcnt lgkmcnt(0)
  s_barrier
  v_mfma_f32_32x32x16_bf16 v[116:131], v[76:79], v[44:47], v[116:131]
  v_mfma_f32_32x32x16_bf16 v[116:131], v[80:83], v[48:51], v[116:131]
  s_nop 15
  s_nop 3
  s_lshl_b32 s17, s14, 6
  s_lshl_b32 s18, s20, 5
  s_add_u32 s17, s17, s18
  v_add_u32 v5, s17, v4
  v_lshlrev_b32 v5, 10, v5
  v_lshl_add_u32 v5, v3, 3, v5
  s_lshl_b32 s24, s15, 7
  s_lshl_b32 s25, s21, 6
  s_add_u32 s24, s24, s25
  v_add_u32 v5, s24, v5
  global_load_dwordx2 v[20:21], v5, s[4:5] offset:0
  global_load_dwordx2 v[22:23], v5, s[4:5] offset:16
  global_load_dwordx2 v[24:25], v5, s[4:5] offset:32
  global_load_dwordx2 v[26:27], v5, s[4:5] offset:48
  s_mov_b32 s38, 0xbfb8aa3b
  v_cvt_pk_bf16_f32 v100, v100, v100
  v_lshlrev_b32 v100, 16, v100
  v_cvt_pk_bf16_f32 v116, v116, v116
  v_lshlrev_b32 v116, 16, v116
  v_mul_f32 v85, s38, v116
  v_exp_f32 v85, v85
  s_nop 0
  v_add_f32 v85, 1.0, v85
  v_rcp_f32 v85, v85
  s_nop 0
  v_mul_f32 v85, v85, v116
  v_cvt_pk_bf16_f32 v85, v85, v85
  v_lshlrev_b32 v85, 16, v85
  v_mul_f32 v85, v85, v100
  v_cvt_pk_bf16_f32 v100, v85, v85
  v_lshlrev_b32 v100, 16, v100
  v_cvt_pk_bf16_f32 v101, v101, v101
  v_lshlrev_b32 v101, 16, v101
  v_cvt_pk_bf16_f32 v117, v117, v117
  v_lshlrev_b32 v117, 16, v117
  v_mul_f32 v85, s38, v117
  v_exp_f32 v85, v85
  s_nop 0
  v_add_f32 v85, 1.0, v85
  v_rcp_f32 v85, v85
  s_nop 0
  v_mul_f32 v85, v85, v117
  v_cvt_pk_bf16_f32 v85, v85, v85
  v_lshlrev_b32 v85, 16, v85
  v_mul_f32 v85, v85, v101
  v_cvt_pk_bf16_f32 v101, v85, v85
  v_lshlrev_b32 v101, 16, v101
  v_cvt_pk_bf16_f32 v102, v102, v102
  v_lshlrev_b32 v102, 16, v102
  v_cvt_pk_bf16_f32 v118, v118, v118
  v_lshlrev_b32 v118, 16, v118
  v_mul_f32 v85, s38, v118
  v_exp_f32 v85, v85
  s_nop 0
  v_add_f32 v85, 1.0, v85
  v_rcp_f32 v85, v85
  s_nop 0
  v_mul_f32 v85, v85, v118
  v_cvt_pk_bf16_f32 v85, v85, v85
  v_lshlrev_b32 v85, 16, v85
  v_mul_f32 v85, v85, v102
  v_cvt_pk_bf16_f32 v102, v85, v85
  v_lshlrev_b32 v102, 16, v102
  v_cvt_pk_bf16_f32 v103, v103, v103
  v_lshlrev_b32 v103, 16, v103
  v_cvt_pk_bf16_f32 v119, v119, v119
  v_lshlrev_b32 v119, 16, v119
  v_mul_f32 v85, s38, v119
  v_exp_f32 v85, v85
  s_nop 0
  v_add_f32 v85, 1.0, v85
  v_rcp_f32 v85, v85
  s_nop 0
  v_mul_f32 v85, v85, v119
  v_cvt_pk_bf16_f32 v85, v85, v85
  v_lshlrev_b32 v85, 16, v85
  v_mul_f32 v85, v85, v103
  v_cvt_pk_bf16_f32 v103, v85, v85
  v_lshlrev_b32 v103, 16, v103
  s_waitcnt vmcnt(0)
  v_lshlrev_b32 v84, 16, v20
  v_add_f32 v100, v84, v100
  v_and_b32 v84, 0xffff0000, v20
  v_add_f32 v101, v84, v101
  v_lshlrev_b32 v84, 16, v21
  v_add_f32 v102, v84, v102
  v_and_b32 v84, 0xffff0000, v21
  v_add_f32 v103, v84, v103
  v_cvt_pk_bf16_f32 v84, v100, v101
  v_cvt_pk_bf16_f32 v85, v102, v103
  global_store_dwordx2 v5, v[84:85], s[10:11] offset:0
  s_nop 0
  v_cvt_pk_bf16_f32 v104, v104, v104
  v_lshlrev_b32 v104, 16, v104
  v_cvt_pk_bf16_f32 v120, v120, v120
  v_lshlrev_b32 v120, 16, v120
  v_mul_f32 v85, s38, v120
  v_exp_f32 v85, v85
  s_nop 0
  v_add_f32 v85, 1.0, v85
  v_rcp_f32 v85, v85
  s_nop 0
  v_mul_f32 v85, v85, v120
  v_cvt_pk_bf16_f32 v85, v85, v85
  v_lshlrev_b32 v85, 16, v85
  v_mul_f32 v85, v85, v104
  v_cvt_pk_bf16_f32 v104, v85, v85
  v_lshlrev_b32 v104, 16, v104
  v_cvt_pk_bf16_f32 v105, v105, v105
  v_lshlrev_b32 v105, 16, v105
  v_cvt_pk_bf16_f32 v121, v121, v121
  v_lshlrev_b32 v121, 16, v121
  v_mul_f32 v85, s38, v121
  v_exp_f32 v85, v85
  s_nop 0
  v_add_f32 v85, 1.0, v85
  v_rcp_f32 v85, v85
  s_nop 0
  v_mul_f32 v85, v85, v121
  v_cvt_pk_bf16_f32 v85, v85, v85
  v_lshlrev_b32 v85, 16, v85
  v_mul_f32 v85, v85, v105
  v_cvt_pk_bf16_f32 v105, v85, v85
  v_lshlrev_b32 v105, 16, v105
  v_cvt_pk_bf16_f32 v106, v106, v106
  v_lshlrev_b32 v106, 16, v106
  v_cvt_pk_bf16_f32 v122, v122, v122
  v_lshlrev_b32 v122, 16, v122
  v_mul_f32 v85, s38, v122
  v_exp_f32 v85, v85
  s_nop 0
  v_add_f32 v85, 1.0, v85
  v_rcp_f32 v85, v85
  s_nop 0
  v_mul_f32 v85, v85, v122
  v_cvt_pk_bf16_f32 v85, v85, v85
  v_lshlrev_b32 v85, 16, v85
  v_mul_f32 v85, v85, v106
  v_cvt_pk_bf16_f32 v106, v85, v85
  v_lshlrev_b32 v106, 16, v106
  v_cvt_pk_bf16_f32 v107, v107, v107
  v_lshlrev_b32 v107, 16, v107
  v_cvt_pk_bf16_f32 v123, v123, v123
  v_lshlrev_b32 v123, 16, v123
  v_mul_f32 v85, s38, v123
  v_exp_f32 v85, v85
  s_nop 0
  v_add_f32 v85, 1.0, v85
  v_rcp_f32 v85, v85
  s_nop 0
  v_mul_f32 v85, v85, v123
  v_cvt_pk_bf16_f32 v85, v85, v85
  v_lshlrev_b32 v85, 16, v85
  v_mul_f32 v85, v85, v107
  v_cvt_pk_bf16_f32 v107, v85, v85
  v_lshlrev_b32 v107, 16, v107
  v_lshlrev_b32 v84, 16, v22
  v_add_f32 v104, v84, v104
  v_and_b32 v84, 0xffff0000, v22
  v_add_f32 v105, v84, v105
  v_lshlrev_b32 v84, 16, v23
  v_add_f32 v106, v84, v106
  v_and_b32 v84, 0xffff0000, v23
  v_add_f32 v107, v84, v107
  v_cvt_pk_bf16_f32 v84, v104, v105
  v_cvt_pk_bf16_f32 v85, v106, v107
  global_store_dwordx2 v5, v[84:85], s[10:11] offset:16
  s_nop 0
  v_cvt_pk_bf16_f32 v108, v108, v108
  v_lshlrev_b32 v108, 16, v108
  v_cvt_pk_bf16_f32 v124, v124, v124
  v_lshlrev_b32 v124, 16, v124
  v_mul_f32 v85, s38, v124
  v_exp_f32 v85, v85
  s_nop 0
  v_add_f32 v85, 1.0, v85
  v_rcp_f32 v85, v85
  s_nop 0
  v_mul_f32 v85, v85, v124
  v_cvt_pk_bf16_f32 v85, v85, v85
  v_lshlrev_b32 v85, 16, v85
  v_mul_f32 v85, v85, v108
  v_cvt_pk_bf16_f32 v108, v85, v85
  v_lshlrev_b32 v108, 16, v108
  v_cvt_pk_bf16_f32 v109, v109, v109
  v_lshlrev_b32 v109, 16, v109
  v_cvt_pk_bf16_f32 v125, v125, v125
  v_lshlrev_b32 v125, 16, v125
  v_mul_f32 v85, s38, v125
  v_exp_f32 v85, v85
  s_nop 0
  v_add_f32 v85, 1.0, v85
  v_rcp_f32 v85, v85
  s_nop 0
  v_mul_f32 v85, v85, v125
  v_cvt_pk_bf16_f32 v85, v85, v85
  v_lshlrev_b32 v85, 16, v85
  v_mul_f32 v85, v85, v109
  v_cvt_pk_bf16_f32 v109, v85, v85
  v_lshlrev_b32 v109, 16, v109
  v_cvt_pk_bf16_f32 v110, v110, v110
  v_lshlrev_b32 v110, 16, v110
  v_cvt_pk_bf16_f32 v126, v126, v126
  v_lshlrev_b32 v126, 16, v126
  v_mul_f32 v85, s38, v126
  v_exp_f32 v85, v85
  s_nop 0
  v_add_f32 v85, 1.0, v85
  v_rcp_f32 v85, v85
  s_nop 0
  v_mul_f32 v85, v85, v126
  v_cvt_pk_bf16_f32 v85, v85, v85
  v_lshlrev_b32 v85, 16, v85
  v_mul_f32 v85, v85, v110
  v_cvt_pk_bf16_f32 v110, v85, v85
  v_lshlrev_b32 v110, 16, v110
  v_cvt_pk_bf16_f32 v111, v111, v111
  v_lshlrev_b32 v111, 16, v111
  v_cvt_pk_bf16_f32 v127, v127, v127
  v_lshlrev_b32 v127, 16, v127
  v_mul_f32 v85, s38, v127
  v_exp_f32 v85, v85
  s_nop 0
  v_add_f32 v85, 1.0, v85
  v_rcp_f32 v85, v85
  s_nop 0
  v_mul_f32 v85, v85, v127
  v_cvt_pk_bf16_f32 v85, v85, v85
  v_lshlrev_b32 v85, 16, v85
  v_mul_f32 v85, v85, v111
  v_cvt_pk_bf16_f32 v111, v85, v85
  v_lshlrev_b32 v111, 16, v111
  v_lshlrev_b32 v84, 16, v24
  v_add_f32 v108, v84, v108
  v_and_b32 v84, 0xffff0000, v24
  v_add_f32 v109, v84, v109
  v_lshlrev_b32 v84, 16, v25
  v_add_f32 v110, v84, v110
  v_and_b32 v84, 0xffff0000, v25
  v_add_f32 v111, v84, v111
  v_cvt_pk_bf16_f32 v84, v108, v109
  v_cvt_pk_bf16_f32 v85, v110, v111
  global_store_dwordx2 v5, v[84:85], s[10:11] offset:32
  s_nop 0
  v_cvt_pk_bf16_f32 v112, v112, v112
  v_lshlrev_b32 v112, 16, v112
  v_cvt_pk_bf16_f32 v128, v128, v128
  v_lshlrev_b32 v128, 16, v128
  v_mul_f32 v85, s38, v128
  v_exp_f32 v85, v85
  s_nop 0
  v_add_f32 v85, 1.0, v85
  v_rcp_f32 v85, v85
  s_nop 0
  v_mul_f32 v85, v85, v128
  v_cvt_pk_bf16_f32 v85, v85, v85
  v_lshlrev_b32 v85, 16, v85
  v_mul_f32 v85, v85, v112
  v_cvt_pk_bf16_f32 v112, v85, v85
  v_lshlrev_b32 v112, 16, v112
  v_cvt_pk_bf16_f32 v113, v113, v113
  v_lshlrev_b32 v113, 16, v113
  v_cvt_pk_bf16_f32 v129, v129, v129
  v_lshlrev_b32 v129, 16, v129
  v_mul_f32 v85, s38, v129
  v_exp_f32 v85, v85
  s_nop 0
  v_add_f32 v85, 1.0, v85
  v_rcp_f32 v85, v85
  s_nop 0
  v_mul_f32 v85, v85, v129
  v_cvt_pk_bf16_f32 v85, v85, v85
  v_lshlrev_b32 v85, 16, v85
  v_mul_f32 v85, v85, v113
  v_cvt_pk_bf16_f32 v113, v85, v85
  v_lshlrev_b32 v113, 16, v113
  v_cvt_pk_bf16_f32 v114, v114, v114
  v_lshlrev_b32 v114, 16, v114
  v_cvt_pk_bf16_f32 v130, v130, v130
  v_lshlrev_b32 v130, 16, v130
  v_mul_f32 v85, s38, v130
  v_exp_f32 v85, v85
  s_nop 0
  v_add_f32 v85, 1.0, v85
  v_rcp_f32 v85, v85
  s_nop 0
  v_mul_f32 v85, v85, v130
  v_cvt_pk_bf16_f32 v85, v85, v85
  v_lshlrev_b32 v85, 16, v85
  v_mul_f32 v85, v85, v114
  v_cvt_pk_bf16_f32 v114, v85, v85
  v_lshlrev_b32 v114, 16, v114
  v_cvt_pk_bf16_f32 v115, v115, v115
  v_lshlrev_b32 v115, 16, v115
  v_cvt_pk_bf16_f32 v131, v131, v131
  v_lshlrev_b32 v131, 16, v131
  v_mul_f32 v85, s38, v131
  v_exp_f32 v85, v85
  s_nop 0
  v_add_f32 v85, 1.0, v85
  v_rcp_f32 v85, v85
  s_nop 0
  v_mul_f32 v85, v85, v131
  v_cvt_pk_bf16_f32 v85, v85, v85
  v_lshlrev_b32 v85, 16, v85
  v_mul_f32 v85, v85, v115
  v_cvt_pk_bf16_f32 v115, v85, v85
  v_lshlrev_b32 v115, 16, v115
  v_lshlrev_b32 v84, 16, v26
  v_add_f32 v112, v84, v112
  v_and_b32 v84, 0xffff0000, v26
  v_add_f32 v113, v84, v113
  v_lshlrev_b32 v84, 16, v27
  v_add_f32 v114, v84, v114
  v_and_b32 v84, 0xffff0000, v27
  v_add_f32 v115, v84, v115
  v_cvt_pk_bf16_f32 v84, v112, v113
  v_cvt_pk_bf16_f32 v85, v114, v115
  global_store_dwordx2 v5, v[84:85], s[10:11] offset:48
  s_nop 0
k3_end:
  s_endpgm
.section .rodata,"a"
.p2align 6
.amdhsa_kernel k1_kernel
  .amdhsa_next_free_vgpr 256
  .amdhsa_next_free_sgpr 102
  .amdhsa_accum_offset 256
  .amdhsa_group_segment_fixed_size 0
  .amdhsa_kernarg_size 80
  .amdhsa_user_sgpr_count 2
  .amdhsa_user_sgpr_kernarg_segment_ptr 1
  .amdhsa_system_sgpr_workgroup_id_x 1
.end_amdhsa_kernel
.p2align 6
.amdhsa_kernel k2_kernel
  .amdhsa_next_free_vgpr 256
  .amdhsa_next_free_sgpr 102
  .amdhsa_accum_offset 256
  .amdhsa_group_segment_fixed_size 0
  .amdhsa_kernarg_size 80
  .amdhsa_user_sgpr_count 2
  .amdhsa_user_sgpr_kernarg_segment_ptr 1
  .amdhsa_system_sgpr_workgroup_id_x 1
.end_amdhsa_kernel
.p2align 6
.amdhsa_kernel recurrent_scan__sliding_block__glu_gated_geglu__prompt_kernel
  .amdhsa_next_free_vgpr 256
  .amdhsa_next_free_sgpr 102
  .amdhsa_accum_offset 256
  .amdhsa_group_segment_fixed_size 0
  .amdhsa_kernarg_size 80
  .amdhsa_user_sgpr_count 2
  .amdhsa_user_sgpr_kernarg_segment_ptr 1
  .amdhsa_system_sgpr_workgroup_id_x 1
.end_amdhsa_kernel
```
